```python
import torch

def _softmax(x, axis=-1):
    return torch.softmax(x, dim=axis)
def _gelu(x):
    return torch.nn.functional.gelu(x, approximate="tanh")
def _silu(x):
    return torch.nn.functional.silu(x)
def _sigmoid(x):
    return torch.sigmoid(x)
def _layernorm(x, axis=-1, eps=1e-5):
    m = x.mean(dim=axis, keepdim=True)
    v = x.var(dim=axis, keepdim=True, unbiased=False)
    return (x - m) / torch.sqrt(v + eps)
def _scatter_add(tgt, idx, src, axis=0):
    return tgt.clone().index_add_(axis, idx, src)
def _segment_sum(src, seg, n):
    out = torch.zeros((n,) + src.shape[1:], dtype=src.dtype)
    return out.index_add_(0, seg, src)
def _pad(x, pw):
    flat = tuple(v for pair in reversed(pw) for v in pair)
    return torch.nn.functional.pad(x, flat)

kernel_name = 'standalone__hybrid_graph_tf_exphormer__graph'

def setup_inputs():

    _w = (lambda a: (lambda t: t.to(torch.bfloat16) if t.is_floating_point() else t)(torch.as_tensor(a)))
    N, deg, D = 50000, 16, 64
    E = N * deg
    exp_deg = 4
    Ee = N * exp_deg
    src = (lambda lo, hi, *s: torch.randint(lo, hi, s))(0, N, E).to(torch.int64)
    dst = (lambda lo, hi, *s: torch.randint(lo, hi, s))(0, N, E).to(torch.int64)
    esrc = (lambda lo, hi, *s: torch.randint(lo, hi, s))(0, N, Ee).to(torch.int64)
    edst = torch.repeat_interleave(torch.arange(N), exp_deg).to(torch.int64)
    deg_cnt = torch.bincount(dst, minlength=N).to(float) + 1.0
    return {
        "x": _w((lambda *s: torch.randn(*s, dtype=torch.bfloat16) * 0.05)(N, D)),
        "src": _w(src),
        "dst": _w(dst),
        "esrc": _w(esrc),
        "edst": _w(edst),
        "deg_inv_sqrt": _w(1.0 / (lambda _x: torch.sqrt(torch.as_tensor(_x)))(deg_cnt)),
        "w_l": _w((lambda *s: torch.randn(*s, dtype=torch.bfloat16) * 0.05)(D, D)),
        "wq": _w((lambda *s: torch.randn(*s, dtype=torch.bfloat16) * 0.05)(D, D)),
        "wk": _w((lambda *s: torch.randn(*s, dtype=torch.bfloat16) * 0.05)(D, D)),
        "wv": _w((lambda *s: torch.randn(*s, dtype=torch.bfloat16) * 0.05)(D, D)),
    }

def reference(x, src, dst, esrc, edst, deg_inv_sqrt, w_l, wq, wk, wv):
    N, D = x.shape
    h = x @ w_l
    msg = h[src] * deg_inv_sqrt[src, None] * deg_inv_sqrt[dst, None]
    h_local = _segment_sum(msg, dst, N)
    q = x @ wq
    k = x @ wk
    v = x @ wv
    e = (q[edst] * k[esrc]).sum(-1) * (D ** -0.5)
    exp_e = torch.exp(e)
    denom = _segment_sum(exp_e[:, None], edst, N)[:, 0] + 1e-9
    alpha = exp_e / denom[edst]
    h_attn = _segment_sum(alpha[:, None] * v[esrc], edst, N)
    return h_local + h_attn
```

```asm
; @launch grid=(256,1,1) block=(1024,1,1) lds=159872
.amdgcn_target "amdgcn-amd-amdhsa--gfx950"
.text
.globl standalone__hybrid_graph_tf_exphormer__graph_kernel
.p2align 8
.type standalone__hybrid_graph_tf_exphormer__graph_kernel,@function
standalone__hybrid_graph_tf_exphormer__graph_kernel:
    s_cmp_ge_u32 s2, 256
    s_cbranch_scc1 K_END
    s_load_dwordx4 s[24:27], s[0:1], 8
    s_load_dwordx2 s[32:33], s[0:1], 96
    s_load_dwordx2 s[28:29], s[0:1], 24
    s_load_dwordx2 s[30:31], s[0:1], 40
    s_load_dwordx4 s[36:39], s[0:1], 48
    s_load_dwordx4 s[40:43], s[0:1], 64
    s_load_dwordx2 s[34:35], s[0:1], 0
    s_load_dwordx2 s[44:45], s[0:1], 80
    s_load_dwordx2 s[98:99], s[0:1], 88
    v_lshrrev_b32 v1, 6, v0
    v_mov_b32 v119, v0
    v_readfirstlane_b32 s3, v1
    v_and_b32 v118, 63, v0
    v_lshlrev_b32 v3, 4, v0
    v_mov_b32 v1, 2130706432
    v_cmp_gt_u32 vcc, 784, v0
    s_mul_i32 s57, s2, 12544
    s_mul_i32 s54, s3, 49
    v_cndmask_b32 v3, v1, v3, vcc
    s_and_b32 s60, s2, 7
    s_lshl_b32 s60, s60, 5
    s_lshr_b32 s55, s2, 3
    s_add_u32 s60, s60, s55
    s_add_u32 s55, s54, 3
    s_lshr_b32 s55, s55, 2
    s_add_u32 s54, s54, 52
    s_lshr_b32 s54, s54, 2
    s_sub_u32 s54, s54, s55
    s_mul_i32 s46, s60, 196
    s_add_u32 s46, s46, s55
    s_sub_i32 s55, 50000, s46
    s_max_i32 s55, s55, 0
    s_min_i32 s47, s54, s55
    s_mul_i32 s51, s3, 6144
    v_lshlrev_b32 v2, 2, v118
    s_lshl_b32 s56, s46, 4
    s_mov_b32 s18, 3200000
    s_mov_b32 s19, 0x00020000
    s_mov_b32 s22, 3200000
    s_mov_b32 s23, 0x00020000
    s_mov_b32 s10, 6586368
    s_mov_b32 s11, 0x00020000
    s_waitcnt lgkmcnt(0)
    s_mov_b32 s8, s32
    s_and_b32 s9, s33, 0xffff
    s_mov_b32 s16, s26
    s_and_b32 s17, s27, 0xffff
    s_mov_b32 s20, s24
    s_and_b32 s21, s25, 0xffff
    s_cmp_lg_u32 s3, 0
    s_cbranch_scc1 K_NOCLR
    s_lshl_b32 s54, s2, 7
    s_add_u32 s54, s54, 5505024
    v_mov_b32 v12, 0
    s_mov_b64 exec, 1
    buffer_store_dword v12, v12, s[8:11], s54 offen sc1
    s_mov_b64 exec, -1
K_NOCLR:
    s_cmp_ge_u32 s3, 13
    s_cbranch_scc1 K_NOEDGELD
    buffer_load_dwordx4 v[4:7], v3, s[16:19], s57 offen nt
    buffer_load_dwordx4 v[8:11], v3, s[20:23], s57 offen nt
K_NOEDGELD:
    s_mov_b32 s16, s28
    s_and_b32 s17, s29, 0xffff
    s_mov_b32 s18, 800000
    s_mov_b32 s19, 0x00020000
    buffer_load_dword v82, v2, s[16:19], s56 offen nt
    v_mov_b32 v14, -1
    v_lshlrev_b32 v13, 4, v119
    v_add_u32 v13, 100364, v13
    ds_write_b32 v13, v14
    v_mov_b32 v18, 0
    v_lshlrev_b32 v19, 2, v119
    v_add_u32 v19, 120832, v19
    s_cmp_ge_u32 s3, 4
    s_cbranch_scc1 K_INIT2
    ds_write_b32 v13, v14 offset:16384
    ds_write_b32 v19, v18
    s_cmp_lg_u32 s3, 0
    s_cbranch_scc1 K_INIT2
    v_mov_b32 v19, 122884
    ds_write_b32 v19, v18
K_INIT2:
    v_lshlrev_b32 v13, 4, v119
    v_add_u32 v13, s57, v13
    v_cmp_gt_u32 vcc, 3200000, v13
    s_mov_b64 s[84:85], vcc
    v_cmp_gt_u32 vcc, 784, v119
    s_and_b64 s[84:85], s[84:85], vcc
    s_waitcnt lgkmcnt(0)
    s_barrier
    s_cmp_lt_u32 s3, 13
    s_cbranch_scc1 K_DMADONE
    s_setprio 3
    s_sub_u32 s63, s3, 13
    s_mov_b32 s54, s63
    s_mov_b32 s16, s30
    s_and_b32 s17, s31, 0xffff
    s_mov_b32 s18, 100000
    s_mov_b32 s19, 0x00020000
    s_lshr_b32 s55, s2, 3
    s_mul_i32 s55, s55, 25
    s_lshr_b32 s55, s55, 5
    s_cmp_eq_u32 s54, 2
    s_cselect_b32 s57, 9, 8
    s_mul_i32 s54, s54, 8
    s_add_u32 s55, s55, s54
    v_lshlrev_b32 v12, 4, v118
K_DISLOOP:
    s_cmp_ge_u32 s55, 25
    s_cselect_b32 s56, 25, 0
    s_sub_u32 s55, s55, s56
    s_lshl_b32 s56, s55, 12
    s_add_u32 m0, s56, 0
    s_cmp_eq_u32 s55, 24
    s_addc_u32 s55, s55, 0
    buffer_load_dwordx4 v12, s[16:19], s56 offen lds
    buffer_load_dwordx4 v12, s[16:19], s56 offen offset:1024 lds
    s_cmp_eq_u32 s56, 98304
    s_cbranch_scc1 K_DISHALF
    buffer_load_dwordx4 v12, s[16:19], s56 offen offset:2048 lds
    buffer_load_dwordx4 v12, s[16:19], s56 offen offset:3072 lds
    s_add_u32 s55, s55, 1
K_DISHALF:
    s_sub_u32 s57, s57, 1
    s_cmp_lg_u32 s57, 0
    s_cbranch_scc1 K_DISLOOP
    s_mov_b32 s16, s38
    s_and_b32 s17, s39, 0xffff
    s_mov_b32 s18, 8192
    s_mov_b32 s19, 0x00020000
    s_mov_b32 s20, s40
    s_and_b32 s21, s41, 0xffff
    s_mov_b32 s22, 8192
    s_mov_b32 s23, 0x00020000
    s_mov_b32 s54, s63
    v_bfe_u32 v12, v118, 4, 1
    v_and_b32 v13, 7, v118
    v_xor_b32 v12, v12, v13
    v_lshrrev_b32 v13, 3, v118
    v_lshlrev_b32 v13, 7, v13
    v_xor_b32 v14, 0, v12
    v_lshl_add_u32 v14, v14, 4, v13
    v_xor_b32 v15, 2, v12
    v_lshl_add_u32 v15, v15, 4, v13
    v_xor_b32 v16, 4, v12
    v_lshl_add_u32 v16, v16, 4, v13
    v_xor_b32 v17, 6, v12
    v_lshl_add_u32 v17, v17, 4, v13
    s_cmp_eq_u32 s54, 2
    s_cbranch_scc1 K_WLV
    s_cmp_eq_u32 s54, 0
    s_cselect_b32 s16, s16, s20
    s_cselect_b32 s17, s17, s21
    s_lshl_b32 s55, s54, 13
    s_add_u32 m0, s55, 123008
    s_mov_b32 s56, 0
    buffer_load_dwordx4 v14, s[16:19], s56 offen lds
    buffer_load_dwordx4 v15, s[16:19], s56 offen offset:1024 lds
    buffer_load_dwordx4 v16, s[16:19], s56 offen offset:2048 lds
    buffer_load_dwordx4 v17, s[16:19], s56 offen offset:3072 lds
    s_add_u32 m0, s55, 127104
    s_mov_b32 s56, 4096
    buffer_load_dwordx4 v14, s[16:19], s56 offen lds
    buffer_load_dwordx4 v15, s[16:19], s56 offen offset:1024 lds
    buffer_load_dwordx4 v16, s[16:19], s56 offen offset:2048 lds
    buffer_load_dwordx4 v17, s[16:19], s56 offen offset:3072 lds
    s_branch K_WQ2
K_WLV:
    v_bfe_u32 v12, v118, 4, 2
    v_lshlrev_b32 v12, 1, v12
    v_and_b32 v14, 7, v118
    v_xor_b32 v12, v12, v14
    v_lshl_add_u32 v14, v12, 4, v13
    s_mov_b32 s16, s36
    s_and_b32 s17, s37, 0xffff
    s_mov_b32 m0, 139392
    s_mov_b32 s56, 0
    buffer_load_dwordx4 v14, s[16:19], s56 offen offset:0 lds
    buffer_load_dwordx4 v14, s[16:19], s56 offen offset:1024 lds
    buffer_load_dwordx4 v14, s[16:19], s56 offen offset:2048 lds
    buffer_load_dwordx4 v14, s[16:19], s56 offen offset:3072 lds
    s_mov_b32 m0, 143488
    s_mov_b32 s56, 4096
    buffer_load_dwordx4 v14, s[16:19], s56 offen offset:0 lds
    buffer_load_dwordx4 v14, s[16:19], s56 offen offset:1024 lds
    buffer_load_dwordx4 v14, s[16:19], s56 offen offset:2048 lds
    buffer_load_dwordx4 v14, s[16:19], s56 offen offset:3072 lds
    s_mov_b32 s16, s42
    s_and_b32 s17, s43, 0xffff
    s_mov_b32 m0, 147584
    s_mov_b32 s56, 0
    buffer_load_dwordx4 v14, s[16:19], s56 offen offset:0 lds
    buffer_load_dwordx4 v14, s[16:19], s56 offen offset:1024 lds
    buffer_load_dwordx4 v14, s[16:19], s56 offen offset:2048 lds
    buffer_load_dwordx4 v14, s[16:19], s56 offen offset:3072 lds
    s_mov_b32 m0, 151680
    s_mov_b32 s56, 4096
    buffer_load_dwordx4 v14, s[16:19], s56 offen offset:0 lds
    buffer_load_dwordx4 v14, s[16:19], s56 offen offset:1024 lds
    buffer_load_dwordx4 v14, s[16:19], s56 offen offset:2048 lds
    buffer_load_dwordx4 v14, s[16:19], s56 offen offset:3072 lds
K_WQ2:
K_DMADONE:
    s_mov_b32 s4, s34
    s_and_b32 s5, s35, 0xffff
    s_mov_b32 s6, 6400000
    s_mov_b32 s7, 0x00020000
    s_mov_b32 s12, s44
    s_and_b32 s13, s45, 0xffff
    s_mov_b32 s14, 6400000
    s_mov_b32 s15, 0x00020000
    s_mov_b32 s48, 0x07060302
    s_mov_b32 s49, 0x000f000f
    s_mov_b32 s50, 128
    v_bfe_u32 v120, v118, 4, 1
    v_lshlrev_b32 v120, 1, v120
    v_and_b32 v121, 7, v118
    v_xor_b32 v120, v120, v121
    v_lshlrev_b32 v112, 4, v120
    v_xor_b32 v113, 64, v112
    v_and_b32 v120, 8, v118
    v_cmp_ne_u32 s[74:75], 0, v120
    v_and_b32 v120, 15, v118
    v_sub_u32 v120, 15, v120
    v_lshl_or_b32 v116, v120, 16, v120
    v_bfe_u32 v120, v118, 3, 1
    v_lshrrev_b32 v121, 4, v118
    v_bfe_u32 v122, v118, 2, 1
    v_lshlrev_b32 v123, 3, v120
    v_lshl_add_u32 v123, v121, 1, v123
    v_add_u32 v123, v123, v122
    v_lshlrev_b32 v123, 7, v123
    v_and_b32 v122, 1, v121
    v_lshl_add_u32 v122, v120, 1, v122
    v_lshl_add_u32 v123, v122, 5, v123
    v_and_b32 v122, 3, v118
    v_lshl_add_u32 v123, v122, 3, v123
    v_add_u32 v108, s51, v123
    v_xor_b32 v109, 32, v108
    v_xor_b32 v110, 64, v108
    v_xor_b32 v111, 96, v108
    v_lshlrev_b32 v126, 4, v118
    v_add_u32 v126, 98304, v126
    v_mov_b32 v36, 0
    v_mov_b32 v37, 0
    v_mov_b32 v38, 0
    v_mov_b32 v39, 0
    v_mov_b32 v60, 0
    v_mov_b32 v61, 0
    v_mov_b32 v62, 0
    v_mov_b32 v63, 0
    v_mov_b32 v64, 0
    v_mov_b32 v65, 0
    v_mov_b32 v66, 0
    v_mov_b32 v67, 0
    v_and_b32 v120, 1, v118
    v_bfe_u32 v121, v118, 2, 2
    v_bfe_u32 v122, v118, 1, 1
    v_lshlrev_b32 v123, 3, v120
    v_lshl_add_u32 v123, v121, 1, v123
    v_add_u32 v123, v123, v122
    v_and_b32 v121, 1, v121
    v_lshl_add_u32 v120, v120, 1, v121
    v_lshlrev_b32 v120, 1, v120
    v_lshrrev_b32 v121, 4, v118
    v_xor_b32 v120, v120, v121
    v_lshlrev_b32 v120, 4, v120
    v_lshl_add_u32 v120, v123, 7, v120
    v_add_u32 v124, s51, v120
    v_xor_b32 v125, 64, v124
    v_lshrrev_b32 v120, 4, v118
    v_and_b32 v121, 3, v118
    v_cmp_eq_u32 s[78:79], v120, v121
    v_and_b32 v120, 4, v118
    v_cmp_ne_u32 s[72:73], 0, v120
    v_and_b32 v120, 8, v118
    v_cmp_ne_u32 vcc, 0, v120
    s_andn2_b64 s[64:65], s[78:79], vcc
    s_and_b64 s[68:69], s[78:79], vcc
    s_and_b64 s[66:67], s[64:65], s[72:73]
    s_andn2_b64 s[64:65], s[64:65], s[72:73]
    s_and_b64 s[70:71], s[68:69], s[72:73]
    s_andn2_b64 s[68:69], s[68:69], s[72:73]
    s_mul_i32 s54, s3, 1152
    s_add_u32 s54, s54, 126976
    v_lshrrev_b32 v120, 4, v118
    v_lshl_add_u32 v114, v120, 4, s54
    s_mul_i32 s54, s3, 576
    s_add_u32 s54, s54, 145408
    v_lshl_add_u32 v115, v120, 3, s54
    v_bfe_u32 v40, v118, 2, 2
    v_and_b32 v41, 3, v118
    v_lshl_add_u32 v41, v40, 3, v41
    v_lshlrev_b32 v41, 7, v41
    v_bfe_u32 v42, v118, 1, 1
    v_lshl_add_u32 v40, v40, 1, v42
    v_lshrrev_b32 v42, 4, v118
    v_xor_b32 v40, v40, v42
    v_lshl_add_u32 v41, v40, 4, v41
    s_lshr_b32 s54, s3, 2
    s_bfe_u32 s55, s3, 0x10001
    s_and_b32 s56, s3, 1
    s_lshl_b32 s55, s55, 5
    s_lshl_b32 s56, s56, 2
    s_add_u32 s55, s55, s56
    s_lshl_b32 s55, s55, 7
    s_add_u32 s55, s55, 123008
    s_lshr_b32 s56, s54, 1
    s_lshl_b32 s56, s56, 5
    s_and_b32 s54, s54, 1
    s_lshl_b32 s54, s54, 2
    s_add_u32 s56, s56, s54
    s_lshl_b32 s56, s56, 7
    s_add_u32 s56, s56, 131200
    v_add_u32 v42, s55, v41
    v_add_u32 v43, s56, v41
    s_mov_b32 s54, 1369569
    s_mov_b32 s55, -49
    s_mov_b32 s56, 43691
    s_mov_b32 s80, 120832
    s_mov_b64 exec, s[84:85]
    s_cbranch_execz K_RANKED
    s_waitcnt vmcnt(2)
    s_cmp_lg_u32 s3, 0
    s_cbranch_scc1 K_NOINI
    s_mov_b64 exec, 1
    s_and_b32 s57, s2, 3
    s_lshl_b32 s57, s57, 6
    v_mov_b32 v12, s57
    v_mov_b32 v13, 1
    global_atomic_add v12, v13, s[98:99]
    s_mov_b64 exec, s[84:85]
K_NOINI:
    v_lshlrev_b32 v16, 8, v4
    v_mul_hi_u32_u24 v16, s54, v16
    v_lshrrev_b32 v32, 4, v16
    v_lshl_add_u32 v28, v32, 2, s80
    v_lshlrev_b32 v17, 8, v5
    v_mul_hi_u32_u24 v17, s54, v17
    v_lshrrev_b32 v33, 4, v17
    v_lshl_add_u32 v29, v33, 2, s80
    v_lshlrev_b32 v18, 8, v6
    v_mul_hi_u32_u24 v18, s54, v18
    v_lshrrev_b32 v34, 4, v18
    v_lshl_add_u32 v30, v34, 2, s80
    v_lshlrev_b32 v19, 8, v7
    v_mul_hi_u32_u24 v19, s54, v19
    v_lshrrev_b32 v35, 4, v19
    v_lshl_add_u32 v31, v35, 2, s80
    v_mov_b32 v36, 1
    ds_add_rtn_u32 v28, v28, v36
    ds_add_rtn_u32 v29, v29, v36
    ds_add_rtn_u32 v30, v30, v36
    ds_add_rtn_u32 v31, v31, v36
    v_lshlrev_b32 v20, 2, v4
    v_mad_i32_i24 v20, v16, s55, v20
    v_lshrrev_b32 v20, 2, v20
    v_lshl_or_b32 v20, v16, 4, v20
    v_lshlrev_b32 v32, 2, v32
    v_add_u32 v32, 121856, v32
    v_lshlrev_b32 v21, 2, v5
    v_mad_i32_i24 v21, v17, s55, v21
    v_lshrrev_b32 v21, 2, v21
    v_lshl_or_b32 v21, v17, 4, v21
    v_lshlrev_b32 v33, 2, v33
    v_add_u32 v33, 121856, v33
    v_lshlrev_b32 v22, 2, v6
    v_mad_i32_i24 v22, v18, s55, v22
    v_lshrrev_b32 v22, 2, v22
    v_lshl_or_b32 v22, v18, 4, v22
    v_lshlrev_b32 v34, 2, v34
    v_add_u32 v34, 121856, v34
    v_lshlrev_b32 v23, 2, v7
    v_mad_i32_i24 v23, v19, s55, v23
    v_lshrrev_b32 v23, 2, v23
    v_lshl_or_b32 v23, v19, 4, v23
    v_lshlrev_b32 v35, 2, v35
    v_add_u32 v35, 121856, v35
    s_waitcnt lgkmcnt(0)
    v_mul_u32_u24 v37, s56, v28
    v_lshrrev_b32 v37, 17, v37
    v_mad_u32_u24 v44, v37, 13, v28
    v_add_lshl_u32 v28, v37, v28, 2
    v_mul_u32_u24 v37, s56, v29
    v_lshrrev_b32 v37, 17, v37
    v_mad_u32_u24 v45, v37, 13, v29
    v_add_lshl_u32 v29, v37, v29, 2
    v_mul_u32_u24 v37, s56, v30
    v_lshrrev_b32 v37, 17, v37
    v_mad_u32_u24 v46, v37, 13, v30
    v_add_lshl_u32 v30, v37, v30, 2
    v_mul_u32_u24 v37, s56, v31
    v_lshrrev_b32 v37, 17, v37
    v_mad_u32_u24 v47, v37, 13, v31
    v_add_lshl_u32 v31, v37, v31, 2
K_RANKED:
    s_mov_b64 exec, 1
    s_cmp_ge_u32 s3, 13
    s_cbranch_scc1 K_NODONE
    v_mov_b32 v12, 122884
    v_mov_b32 v13, 1
    ds_add_u32 v12, v13
K_NODONE:
    s_mov_b64 exec, -1
    s_cmp_lg_u32 s3, 0
    s_cbranch_scc1 K_NOSCAN
    s_setprio 3
    v_mov_b32 v12, 122884
K_DONESPIN:
    ds_read_b32 v13, v12
    s_waitcnt lgkmcnt(0)
    v_readfirstlane_b32 s54, v13
    s_nop 3
    s_cmp_lt_u32 s54, 13
    s_cbranch_scc1 K_DONESPIN
    v_lshlrev_b32 v12, 4, v118
    v_add_u32 v13, 120832, v12
    ds_read_b128 v[48:51], v13
    s_mov_b32 s56, 43691
    s_waitcnt lgkmcnt(0)
    v_add_u32 v48, 2, v48
    v_add_u32 v49, 2, v49
    v_add_u32 v50, 2, v50
    v_add_u32 v51, 2, v51
    v_mul_u32_u24 v48, s56, v48
    v_mul_u32_u24 v49, s56, v49
    v_mul_u32_u24 v50, s56, v50
    v_mul_u32_u24 v51, s56, v51
    v_lshrrev_b32 v48, 17, v48
    v_lshrrev_b32 v49, 17, v49
    v_lshrrev_b32 v50, 17, v50
    v_lshrrev_b32 v51, 17, v51
    v_add_u32 v52, v48, v49
    v_add_u32 v53, v52, v50
    v_add_u32 v54, v53, v51
    v_mov_b32 v55, v54
    s_nop 1
    v_add_u32_dpp v55, v55, v55 row_shr:1 row_mask:0xf bank_mask:0xf
    s_nop 1
    v_add_u32_dpp v55, v55, v55 row_shr:2 row_mask:0xf bank_mask:0xf
    s_nop 1
    v_add_u32_dpp v55, v55, v55 row_shr:4 row_mask:0xf bank_mask:0xf
    s_nop 1
    v_add_u32_dpp v55, v55, v55 row_shr:8 row_mask:0xf bank_mask:0xf
    s_nop 1
    v_add_u32_dpp v55, v55, v55 row_bcast:15 row_mask:0xa bank_mask:0xf
    s_nop 1
    v_add_u32_dpp v55, v55, v55 row_bcast:31 row_mask:0xc bank_mask:0xf
    s_nop 1
    v_sub_u32 v56, v55, v54
    v_lshl_or_b32 v58, v48, 16, v56
    v_add_u32 v57, v56, v48
    v_lshl_or_b32 v59, v49, 16, v57
    v_add_u32 v57, v56, v52
    v_lshl_or_b32 v60, v50, 16, v57
    v_add_u32 v57, v56, v53
    v_lshl_or_b32 v61, v51, 16, v57
    v_add_u32 v13, 121856, v12
    ds_write_b128 v13, v[58:61]
    v_mov_b32 v13, 122880
    s_mov_b32 exec_lo, 0
    s_mov_b32 exec_hi, 0x80000000
    ds_write_b32 v13, v55
    s_mov_b64 exec, -1
K_NOSCAN:
    s_cmp_ge_u32 s3, 13
    s_cbranch_scc1 K_EA0
    s_waitcnt vmcnt(0)
    s_lshl_b32 s54, s3, 8
    s_add_u32 s54, s54, 155776
    v_lshl_add_u32 v122, v118, 2, s54
    v_lshrrev_b32 v120, 2, v118
    v_cmp_gt_u32 vcc, s47, v120
    v_mov_b32 v120, 0xffff
    v_lshrrev_b32 v121, 4, v118
    v_bfe_u32 v123, v118, 3, 1
    v_cndmask_b32 v120, v120, v82, vcc
    ds_write_b32 v122, v120
    v_lshlrev_b32 v121, 4, v121
    v_lshl_add_u32 v121, v123, 3, v121
    v_add_u32 v121, s54, v121
    ds_read_b64 v[60:61], v121 offset:0
    ds_read_b64 v[62:63], v121 offset:64
    ds_read_b64 v[64:65], v121 offset:128
    ds_read_b64 v[66:67], v121 offset:192
    v_lshrrev_b32 v120, 3, v118
    v_add_u32 v120, s46, v120
    v_lshl_add_u32 v36, v120, 7, v112
    v_add_u32 v120, 8, v120
    v_lshl_add_u32 v37, v120, 7, v113
    v_and_b32 v120, 15, v118
    v_bfe_u32 v121, v118, 3, 1
    v_bfe_u32 v122, v118, 1, 1
    v_lshl_add_u32 v121, v121, 1, v122
    v_lshlrev_b32 v121, 1, v121
    v_lshrrev_b32 v122, 4, v118
    v_xor_b32 v121, v121, v122
    v_lshlrev_b32 v121, 4, v121
    v_lshl_add_u32 v120, v120, 7, v121
    v_add_u32 v38, s51, v120
    v_xor_b32 v39, 64, v38
    s_waitcnt lgkmcnt(0)
    v_mad_u32_u16 v60, v60, s50, v112
    v_mad_u32_u16 v61, v61, s50, v113
    v_mad_u32_u16 v62, v62, s50, v112
    v_mad_u32_u16 v63, v63, s50, v113
    v_mad_u32_u16 v64, v64, s50, v112
    v_mad_u32_u16 v65, v65, s50, v113
    v_mad_u32_u16 v66, v66, s50, v112
    v_mad_u32_u16 v67, v67, s50, v113
K_EA0:
    s_cmp_eq_u32 s3, 15
    s_cbranch_scc1 K_BA1X
    s_cmp_ge_u32 s3, 13
    s_cbranch_scc1 K_BA1W
    s_waitcnt vmcnt(0) lgkmcnt(0)
    s_branch K_BA1
K_BA1X:
    s_waitcnt vmcnt(16) lgkmcnt(0)
    s_branch K_BA1
K_BA1W:
    s_waitcnt vmcnt(8) lgkmcnt(0)
K_BA1:
    s_barrier
    s_setprio 0
    s_cmp_lt_u32 s3, 13
    s_cbranch_scc1 K_TOUCHED
    s_mul_i32 s55, s60, 25088
    s_lshl_b32 s56, s63, 13
    s_add_u32 s55, s55, s56
    s_mov_b32 s16, s34
    s_and_b32 s17, s35, 0xffff
    s_mov_b32 s18, 6400000
    v_lshlrev_b32 v12, 7, v118
    buffer_load_dword v80, v12, s[16:19], s55 offen
    s_cmp_lg_u32 s63, 2
    s_cbranch_scc1 K_TOUCHED
    s_add_u32 s55, s55, 8192
    s_mov_b64 exec, 0xf
    buffer_load_dword v81, v12, s[16:19], s55 offen
    s_mov_b64 exec, -1
K_TOUCHED:
    s_cmp_lt_u32 s3, 13
    s_cbranch_scc1 K_EA1
    s_lshl_b32 s54, s3, 8
    s_add_u32 s54, s54, 155776
    v_lshl_add_u32 v122, v118, 2, s54
    v_lshrrev_b32 v120, 2, v118
    v_cmp_gt_u32 vcc, s47, v120
    v_mov_b32 v120, 0xffff
    v_lshrrev_b32 v121, 4, v118
    v_bfe_u32 v123, v118, 3, 1
    v_cndmask_b32 v120, v120, v82, vcc
    ds_write_b32 v122, v120
    v_lshlrev_b32 v121, 4, v121
    v_lshl_add_u32 v121, v123, 3, v121
    v_add_u32 v121, s54, v121
    ds_read_b64 v[60:61], v121 offset:0
    ds_read_b64 v[62:63], v121 offset:64
    ds_read_b64 v[64:65], v121 offset:128
    ds_read_b64 v[66:67], v121 offset:192
    v_lshrrev_b32 v120, 3, v118
    v_add_u32 v120, s46, v120
    v_lshl_add_u32 v36, v120, 7, v112
    v_add_u32 v120, 8, v120
    v_lshl_add_u32 v37, v120, 7, v113
    v_and_b32 v120, 15, v118
    v_bfe_u32 v121, v118, 3, 1
    v_bfe_u32 v122, v118, 1, 1
    v_lshl_add_u32 v121, v121, 1, v122
    v_lshlrev_b32 v121, 1, v121
    v_lshrrev_b32 v122, 4, v118
    v_xor_b32 v121, v121, v122
    v_lshlrev_b32 v121, 4, v121
    v_lshl_add_u32 v120, v120, 7, v121
    v_add_u32 v38, s51, v120
    v_xor_b32 v39, 64, v38
    s_waitcnt lgkmcnt(0)
    v_mad_u32_u16 v60, v60, s50, v112
    v_mad_u32_u16 v61, v61, s50, v113
    v_mad_u32_u16 v62, v62, s50, v112
    v_mad_u32_u16 v63, v63, s50, v113
    v_mad_u32_u16 v64, v64, s50, v112
    v_mad_u32_u16 v65, v65, s50, v113
    v_mad_u32_u16 v66, v66, s50, v112
    v_mad_u32_u16 v67, v67, s50, v113
K_EA1:
    s_cmp_lg_u32 s3, 0
    s_cbranch_scc1 K_NOINI2
    v_lshlrev_b32 v80, 6, v118
    s_mov_b64 exec, 0xf
    global_load_dword v83, v80, s[98:99] sc1
    s_mov_b64 exec, -1
K_NOINI2:
    v_and_b32 v117, 15, v118
    v_add_u32 v117, s46, v117
    v_lshlrev_b32 v117, 1, v117
    ds_read_u16 v117, v117 offset:0
    s_mov_b64 exec, s[84:85]
    s_cbranch_execz K_NOEDGE
    v_lshlrev_b32 v24, 1, v8
    ds_read_b32 v32, v32
    ds_read_u16 v24, v24 offset:0
    v_lshlrev_b32 v25, 1, v9
    ds_read_b32 v33, v33
    ds_read_u16 v25, v25 offset:0
    v_lshlrev_b32 v26, 1, v10
    ds_read_b32 v34, v34
    ds_read_u16 v26, v26 offset:0
    v_lshlrev_b32 v27, 1, v11
    ds_read_b32 v35, v35
    ds_read_u16 v27, v27 offset:0
    s_waitcnt lgkmcnt(0)
    v_and_b32 v32, 0xffff, v32
    v_lshlrev_b32 v32, 4, v32
    v_lshl_or_b32 v24, v24, 16, v8
    v_add_u32 v32, 100352, v32
    v_add_u32 v28, v28, v32
    v_add_u32 v44, v44, v32
    ds_write_b32 v28, v24
    ds_write_b8 v44, v20 offset:12
    v_and_b32 v33, 0xffff, v33
    v_lshlrev_b32 v33, 4, v33
    v_lshl_or_b32 v25, v25, 16, v9
    v_add_u32 v33, 100352, v33
    v_add_u32 v29, v29, v33
    v_add_u32 v45, v45, v33
    ds_write_b32 v29, v25
    ds_write_b8 v45, v21 offset:12
    v_and_b32 v34, 0xffff, v34
    v_lshlrev_b32 v34, 4, v34
    v_lshl_or_b32 v26, v26, 16, v10
    v_add_u32 v34, 100352, v34
    v_add_u32 v30, v30, v34
    v_add_u32 v46, v46, v34
    ds_write_b32 v30, v26
    ds_write_b8 v46, v22 offset:12
    v_and_b32 v35, 0xffff, v35
    v_lshlrev_b32 v35, 4, v35
    v_lshl_or_b32 v27, v27, 16, v11
    v_add_u32 v35, 100352, v35
    v_add_u32 v31, v31, v35
    v_add_u32 v47, v47, v35
    ds_write_b32 v31, v27
    ds_write_b8 v47, v23 offset:12
K_NOEDGE:
    s_mov_b64 exec, -1
    s_mov_b64 exec, -1
    s_cmp_lt_u32 s3, 13
    s_cbranch_scc1 K_BA2W
    s_cmp_eq_u32 s3, 15
    s_cbranch_scc1 K_BA2X
    s_waitcnt vmcnt(1)
    s_branch K_BA2W
K_BA2X:
    s_waitcnt vmcnt(2)
K_BA2W:
    s_waitcnt lgkmcnt(0)
    s_barrier
    v_mov_b32 v29, 122880
    ds_read_b32 v30, v29
    v_lshlrev_b32 v6, 4, v119
    v_add_u32 v7, 100352, v6
    ds_read_b128 v[8:11], v7
    ds_read_b128 v[12:15], v7 offset:16384
    v_xor_b32 v40, 64, v42
    v_xor_b32 v41, 64, v43
    ds_read_b128 v[44:47], v42
    ds_read_b128 v[48:51], v43
    ds_read_b128 v[52:55], v40
    ds_read_b128 v[56:59], v41
    s_mul_i32 s54, s2, 20480
    v_mov_b32 v28, 2130706432
    v_add_u32 v19, 1024, v119
    v_add_u32 v18, 16384, v6
    s_waitcnt lgkmcnt(6)
    v_cmp_gt_u32 vcc, v30, v119
    v_cmp_gt_u32 s[96:97], v30, v19
    v_readfirstlane_b32 s55, v30
    v_cndmask_b32 v6, v28, v6, vcc
    v_cndmask_b32 v18, v28, v18, s[96:97]
    s_waitcnt lgkmcnt(5)
    buffer_store_dwordx4 v[8:11], v6, s[8:11], s54 offen sc1
    s_lshl_b32 s56, s3, 6
    s_add_u32 s56, s56, 1024
    s_cmp_ge_u32 s56, s55
    s_cbranch_scc1 K_NOST2
    s_waitcnt lgkmcnt(4)
    buffer_store_dwordx4 v[12:15], v18, s[8:11], s54 offen sc1
K_NOST2:
    s_cmp_lg_u32 s3, 15
    s_cbranch_scc1 K_NOOFT
    v_lshlrev_b32 v20, 4, v118
    v_add_u32 v21, 121856, v20
    ds_read_b128 v[24:27], v21
    s_lshl_b32 s56, s2, 10
    s_add_u32 s56, s56, 5242880
    s_waitcnt lgkmcnt(0)
    buffer_store_dwordx4 v[24:27], v20, s[8:11], s56 offen sc1
K_NOOFT:
    v_lshrrev_b32 v20, 4, v118
    v_bfe_u32 v21, v118, 2, 2
    v_lshl_add_u32 v22, v20, 2, v21
    v_lshlrev_b32 v22, 7, v22
    v_and_b32 v20, 1, v20
    v_lshrrev_b32 v21, 1, v21
    v_lshl_add_u32 v20, v20, 1, v21
    s_bfe_u32 s54, s3, 0x20001
    v_xor_b32 v20, s54, v20
    v_lshl_add_u32 v22, v20, 5, v22
    v_and_b32 v20, 3, v118
    v_lshl_add_u32 v22, v20, 3, v22
    s_lshr_b32 s54, s3, 3
    s_lshl_b32 s54, s54, 13
    s_and_b32 s55, s3, 1
    s_lshl_b32 s55, s55, 12
    s_add_u32 s54, s54, s55
    s_add_u32 s54, s54, 139392
    v_add_u32 v22, s54, v22
    ds_read_b64_tr_b16 v[68:69], v22
    ds_read_b64_tr_b16 v[70:71], v22 offset:2048
    s_waitcnt lgkmcnt(0)
    v_mfma_f32_16x16x32_bf16 v[76:79], v[44:47], v[48:51], 0
    v_mfma_f32_16x16x32_bf16 v[76:79], v[52:55], v[56:59], v[76:79]
    s_barrier
    s_lshl_b32 s54, s3, 10
    v_add_u32 v120, s54, v126
    ds_write_b128 v120, v[68:71] offset:8192
    s_lshr_b32 s54, s3, 1
    s_lshl_b32 s54, s54, 10
    s_and_b32 s55, s3, 1
    s_lshl_b32 s55, s55, 3
    s_add_u32 s54, s54, s55
    v_add_u32 v121, s54, v126
    v_mul_u32_u24 v40, 2048, v118
    v_mov_b32 v41, 1
    v_cvt_pk_bf16_f32 v72, v76, v77
    v_cvt_pk_bf16_f32 v73, v78, v79
    ds_write_b64 v121, v[72:73]
    v_mov_b32 v32, 0xffff
    v_mov_b32 v33, 0xffff
    v_mov_b32 v34, 0xffff
    v_mov_b32 v35, 0xffff
    s_mul_i32 s54, s3, 1152
    s_add_u32 s54, s54, 126976
    v_lshl_add_u32 v120, v118, 4, s54
    s_lshl_b32 s55, s3, 2
    s_add_u32 s55, s55, 154624
    v_mov_b32 v121, 0
    v_mov_b32 v122, s55
    ds_write_b128 v120, v[32:35]
    s_mov_b64 exec, 0xff
    ds_write_b128 v120, v[32:35] offset:1024
    s_mov_b64 exec, 1
    ds_write_b32 v122, v121
    s_mov_b64 exec, -1
    s_mov_b32 s80, 154624
    s_mov_b32 s81, 126976
    s_mov_b32 s82, 145408
    s_mov_b32 s83, 288
    s_mov_b32 s62, 0
    s_and_b32 s63, s2, 15
    s_lshl_b32 s63, s63, 7
    s_add_u32 s63, s63, 5505024
    s_cmp_lg_u32 s3, 0
    s_cbranch_scc1 K_INIOK
    s_mov_b32 s54, 0
    v_lshlrev_b32 v80, 6, v118
    s_waitcnt vmcnt(0)
K_INICHK:
    v_cmp_ne_u32 vcc, 64, v83
    s_and_b64 vcc, vcc, 0xf
    s_cmp_eq_u64 vcc, 0
    s_cbranch_scc1 K_INIOK
    s_add_u32 s54, s54, 1
    s_cmp_lt_u32 s54, 40000
    s_cbranch_scc0 K_INIFAIL
    s_sleep 1
    s_mov_b64 exec, 0xf
    global_load_dword v83, v80, s[98:99] sc1
    s_mov_b64 exec, -1
    s_waitcnt vmcnt(0)
    s_branch K_INICHK
K_INIFAIL:
    s_mov_b32 s62, 1
K_INIOK:
    s_cmp_lg_u32 s3, 0
    s_cbranch_scc1 K_NOFLG
    v_mov_b32 v120, 154692
    v_mov_b32 v121, s62
    ds_write_b32 v120, v121
K_NOFLG:
    s_waitcnt vmcnt(0) lgkmcnt(0)
    s_barrier
    s_cmp_lg_u32 s3, 0
    s_cbranch_scc1 K_NOSIG
    s_mov_b64 exec, 0xffff
    buffer_atomic_add v41, v40, s[8:11], s63 offen
    s_mov_b64 exec, -1
K_NOSIG:
    s_add_u32 m0, s51, 4096
    s_nop 0
    buffer_load_dwordx4 v36, s[4:7], 0 offen lds
    s_add_u32 m0, s51, 5120
    s_nop 0
    buffer_load_dwordx4 v37, s[4:7], 0 offen lds
    s_add_u32 m0, s51, 0
    s_nop 0
    buffer_load_dwordx4 v60, s[4:7], 0 offen lds
    s_add_u32 m0, s51, 1024
    s_nop 0
    buffer_load_dwordx4 v61, s[4:7], 0 offen lds
    v_mov_b32 v121, 154692
    ds_read_b32 v122, v121
    v_lshrrev_b32 v120, 2, v118
    v_lshlrev_b32 v120, 4, v120
    v_add_u32 v120, s3, v120
    v_lshlrev_b32 v72, 10, v120
    s_mov_b32 s54, 20480
    v_mul_u32_u24 v73, s54, v120
    v_and_b32 v74, 3, v118
    s_lshl_b32 s57, s60, 2
    s_add_u32 s57, s57, 5242880
    s_mov_b32 s58, 0
    s_and_b32 s55, s2, 15
    s_mul_i32 s55, s55, 2048
    s_lshl_b32 s56, s3, 7
    s_add_u32 s55, s55, s56
    s_add_u32 s55, s55, 5505024
    s_add_u32 s76, s32, s55
    s_addc_u32 s77, s33, 0
    s_waitcnt lgkmcnt(0)
    v_readfirstlane_b32 s62, v122
    s_waitcnt vmcnt(2)
    ds_read_b128 v[68:71], v38 offset:4096
    ds_read_b128 v[76:79], v39 offset:4096
    s_waitcnt lgkmcnt(0)
    ds_read_b128 v[32:35], v126 offset:0
    ds_read_b128 v[36:39], v126 offset:1024
    ds_read_b128 v[40:43], v126 offset:2048
    ds_read_b128 v[44:47], v126 offset:3072
    s_waitcnt lgkmcnt(2)
    v_mfma_f32_16x16x32_bf16 v[16:19], v[32:35], v[68:71], 0
    v_mfma_f32_16x16x32_bf16 v[16:19], v[36:39], v[76:79], v[16:19]
    s_waitcnt lgkmcnt(0)
    v_mfma_f32_16x16x32_bf16 v[20:23], v[40:43], v[68:71], 0
    v_mfma_f32_16x16x32_bf16 v[20:23], v[44:47], v[76:79], v[20:23]
    ds_read_b128 v[32:35], v126 offset:4096
    ds_read_b128 v[36:39], v126 offset:5120
    ds_read_b128 v[40:43], v126 offset:6144
    ds_read_b128 v[44:47], v126 offset:7168
    s_waitcnt lgkmcnt(2)
    v_mfma_f32_16x16x32_bf16 v[24:27], v[32:35], v[68:71], 0
    v_mfma_f32_16x16x32_bf16 v[24:27], v[36:39], v[76:79], v[24:27]
    s_waitcnt lgkmcnt(0)
    v_mfma_f32_16x16x32_bf16 v[28:31], v[40:43], v[68:71], 0
    v_mfma_f32_16x16x32_bf16 v[28:31], v[44:47], v[76:79], v[28:31]
    s_nop 2
    v_cvt_pk_bf16_f32 v84, v16, v17
    v_cvt_pk_bf16_f32 v85, v18, v19
    v_cvt_pk_bf16_f32 v86, v20, v21
    v_cvt_pk_bf16_f32 v87, v22, v23
    v_cvt_pk_bf16_f32 v88, v24, v25
    v_cvt_pk_bf16_f32 v89, v26, v27
    v_cvt_pk_bf16_f32 v90, v28, v29
    v_cvt_pk_bf16_f32 v91, v30, v31
    s_mov_b32 s54, 0
    s_cmp_lg_u32 s62, 0
    s_cbranch_scc1 K_POLL_DONE
K_POLL:
    s_load_dword s55, s[76:77], 0 glc
    s_add_u32 s54, s54, 1
    s_waitcnt lgkmcnt(0)
    s_cmp_eq_u32 s55, 16
    s_cbranch_scc1 K_POLL_DONE
    s_cmp_lt_u32 s54, 40000
    s_cbranch_scc1 K_POLL
    s_mov_b32 s62, 1
    v_mov_b32 v120, 154692
    v_mov_b32 v121, 1
    ds_write_b32 v120, v121
K_POLL_DONE:
    buffer_load_dword v48, v72, s[8:11], s57 offen sc1
    s_add_u32 m0, s51, 2048
    s_nop 0
    buffer_load_dwordx4 v62, s[4:7], 0 offen lds
    s_add_u32 m0, s51, 3072
    s_nop 0
    buffer_load_dwordx4 v63, s[4:7], 0 offen lds
    v_mov_b32 v122, 2130706432
    s_waitcnt vmcnt(2)
    v_and_b32 v120, 0xffff, v48
    v_lshrrev_b32 v48, 16, v48
    v_add_u32 v120, v120, v74
    v_lshl_add_u32 v49, v120, 4, v73
    v_cmp_gt_u32 s[76:77], v48, v74
    v_add_u32 v121, 4, v74
    v_cmp_gt_u32 s[78:79], v48, v121
    s_cmp_lg_u32 s62, 0
    s_cselect_b64 s[76:77], 0, s[76:77]
    s_cselect_b64 s[78:79], 0, s[78:79]
    v_add_u32 v121, 64, v49
    v_cndmask_b32 v120, v122, v49, s[76:77]
    v_cndmask_b32 v121, v122, v121, s[78:79]
    buffer_load_dwordx4 v[0:3], v120, s[8:11], 0 offen sc1
    buffer_load_dwordx4 v[4:7], v121, s[8:11], 0 offen sc1
    s_waitcnt vmcnt(2)
    ds_read_b128 v[92:95], v124 offset:0
    ds_read_b128 v[96:99], v125 offset:0
    ds_read_b128 v[100:103], v124 offset:2048
    ds_read_b128 v[104:107], v125 offset:2048
    ds_read_b64_tr_b16 v[32:33], v108 offset:0
    ds_read_b64_tr_b16 v[36:37], v109 offset:0
    ds_read_b64_tr_b16 v[40:41], v110 offset:0
    ds_read_b64_tr_b16 v[44:45], v111 offset:0
    ds_read_b64_tr_b16 v[34:35], v108 offset:2048
    ds_read_b64_tr_b16 v[38:39], v109 offset:2048
    ds_read_b64_tr_b16 v[42:43], v110 offset:2048
    ds_read_b64_tr_b16 v[46:47], v111 offset:2048
    s_waitcnt lgkmcnt(0)
    v_mfma_f32_16x16x32_bf16 v[56:59], v[92:95], v[84:87], 0
    v_mfma_f32_16x16x32_bf16 v[68:71], v[100:103], v[84:87], 0
    v_mfma_f32_16x16x32_bf16 v[56:59], v[96:99], v[88:91], v[56:59]
    v_mfma_f32_16x16x32_bf16 v[68:71], v[104:107], v[88:91], v[68:71]
    s_mov_b32 s54, 0x3e38aa3b
    s_mov_b32 s55, 0x3089705f
    s_nop 6
    v_cndmask_b32 v56, v56, v68, s[72:73]
    v_cndmask_b32 v57, v57, v69, s[72:73]
    v_cndmask_b32 v58, v58, v70, s[72:73]
    v_cndmask_b32 v59, v59, v71, s[72:73]
    v_mul_f32 v56, s54, v56
    v_mul_f32 v57, s54, v57
    v_mul_f32 v58, s54, v58
    v_mul_f32 v59, s54, v59
    v_exp_f32 v56, v56
    v_exp_f32 v57, v57
    v_exp_f32 v58, v58
    v_exp_f32 v59, v59
    s_nop 0
    v_add_f32 v120, v56, v57
    v_add_f32 v121, v58, v59
    v_add_f32 v120, v120, v121
    v_add_f32 v120, s55, v120
    v_rcp_f32 v120, v120
    s_nop 0
    v_mul_f32 v56, v120, v56
    v_mul_f32 v57, v120, v57
    v_mul_f32 v58, v120, v58
    v_mul_f32 v59, v120, v59
    v_cvt_pk_bf16_f32 v120, v56, v58
    v_cvt_pk_bf16_f32 v121, v57, v59
    v_cndmask_b32 v68, 0, v120, s[64:65]
    v_cndmask_b32 v69, 0, v121, s[64:65]
    v_cndmask_b32 v70, 0, v120, s[66:67]
    v_cndmask_b32 v71, 0, v121, s[66:67]
    s_nop 1
    v_mfma_f32_16x16x32_bf16 v[16:19], v[32:35], v[68:71], 0
    v_mfma_f32_16x16x32_bf16 v[20:23], v[36:39], v[68:71], 0
    v_mfma_f32_16x16x32_bf16 v[24:27], v[40:43], v[68:71], 0
    v_mfma_f32_16x16x32_bf16 v[28:31], v[44:47], v[68:71], 0
    s_waitcnt vmcnt(0)
    s_add_u32 m0, s51, 4096
    s_nop 0
    buffer_load_dwordx4 v64, s[4:7], 0 offen lds
    s_add_u32 m0, s51, 5120
    s_nop 0
    buffer_load_dwordx4 v65, s[4:7], 0 offen lds
    s_cmp_lg_u32 s62, 0
    s_cbranch_scc1 K_NOBIN
    v_cndmask_b32 v3, -1, v3, s[76:77]
    v_cndmask_b32 v7, -1, v7, s[78:79]
    v_mov_b32 v120, 1
    v_bfe_u32 v40, v3, 0, 4
    v_bfe_u32 v32, v3, 4, 4
    v_cmp_ne_u32 s[84:85], 15, v40
    v_lshl_add_u32 v72, v32, 2, s80
    v_bfe_u32 v41, v3, 8, 4
    v_bfe_u32 v33, v3, 12, 4
    v_cmp_ne_u32 s[86:87], 15, v41
    v_lshl_add_u32 v73, v33, 2, s80
    v_bfe_u32 v42, v3, 16, 4
    v_bfe_u32 v34, v3, 20, 4
    v_cmp_ne_u32 s[88:89], 15, v42
    v_lshl_add_u32 v74, v34, 2, s80
    v_bfe_u32 v43, v7, 0, 4
    v_bfe_u32 v35, v7, 4, 4
    v_cmp_ne_u32 s[90:91], 15, v43
    v_lshl_add_u32 v75, v35, 2, s80
    v_bfe_u32 v44, v7, 8, 4
    v_bfe_u32 v36, v7, 12, 4
    v_cmp_ne_u32 s[92:93], 15, v44
    v_lshl_add_u32 v76, v36, 2, s80
    v_bfe_u32 v45, v7, 16, 4
    v_bfe_u32 v37, v7, 20, 4
    v_cmp_ne_u32 s[94:95], 15, v45
    v_lshl_add_u32 v77, v37, 2, s80
    s_mov_b64 exec, s[84:85]
    ds_add_rtn_u32 v72, v72, v120
    s_mov_b64 exec, s[86:87]
    ds_add_rtn_u32 v73, v73, v120
    s_mov_b64 exec, s[88:89]
    ds_add_rtn_u32 v74, v74, v120
    s_mov_b64 exec, s[90:91]
    ds_add_rtn_u32 v75, v75, v120
    s_mov_b64 exec, s[92:93]
    ds_add_rtn_u32 v76, v76, v120
    s_mov_b64 exec, s[94:95]
    ds_add_rtn_u32 v77, v77, v120
    s_mov_b64 exec, -1
    v_lshlrev_b32 v40, v40, 1
    v_lshlrev_b32 v41, v41, 1
    v_lshlrev_b32 v42, v42, 1
    v_lshlrev_b32 v43, v43, 1
    v_lshlrev_b32 v44, v44, 1
    v_lshlrev_b32 v45, v45, 1
    s_waitcnt lgkmcnt(5)
    v_min_u32 v72, 287, v72
    v_mad_u32_u24 v32, v32, s83, v72
    v_lshl_add_u32 v72, v32, 2, s81
    v_lshl_add_u32 v32, v32, 1, s82
    s_waitcnt lgkmcnt(4)
    v_min_u32 v73, 287, v73
    v_mad_u32_u24 v33, v33, s83, v73
    v_lshl_add_u32 v73, v33, 2, s81
    v_lshl_add_u32 v33, v33, 1, s82
    s_waitcnt lgkmcnt(3)
    v_min_u32 v74, 287, v74
    v_mad_u32_u24 v34, v34, s83, v74
    v_lshl_add_u32 v74, v34, 2, s81
    v_lshl_add_u32 v34, v34, 1, s82
    s_waitcnt lgkmcnt(2)
    v_min_u32 v75, 287, v75
    v_mad_u32_u24 v35, v35, s83, v75
    v_lshl_add_u32 v75, v35, 2, s81
    v_lshl_add_u32 v35, v35, 1, s82
    s_waitcnt lgkmcnt(1)
    v_min_u32 v76, 287, v76
    v_mad_u32_u24 v36, v36, s83, v76
    v_lshl_add_u32 v76, v36, 2, s81
    v_lshl_add_u32 v36, v36, 1, s82
    s_waitcnt lgkmcnt(0)
    v_min_u32 v77, 287, v77
    v_mad_u32_u24 v37, v37, s83, v77
    v_lshl_add_u32 v77, v37, 2, s81
    v_lshl_add_u32 v37, v37, 1, s82
    s_mov_b64 exec, s[84:85]
    ds_write_b32 v72, v0
    ds_write_b16 v32, v40
    s_mov_b64 exec, s[86:87]
    ds_write_b32 v73, v1
    ds_write_b16 v33, v41
    s_mov_b64 exec, s[88:89]
    ds_write_b32 v74, v2
    ds_write_b16 v34, v42
    s_mov_b64 exec, s[90:91]
    ds_write_b32 v75, v4
    ds_write_b16 v35, v43
    s_mov_b64 exec, s[92:93]
    ds_write_b32 v76, v5
    ds_write_b16 v36, v44
    s_mov_b64 exec, s[94:95]
    ds_write_b32 v77, v6
    ds_write_b16 v37, v45
    s_mov_b64 exec, -1
K_MORE:
    v_cmp_lt_u32 vcc, 8, v48
    s_cmp_eq_u64 vcc, 0
    s_cbranch_scc1 K_NOBIN
    v_subrev_u32 v48, 8, v48
    v_max_i32 v48, 0, v48
    v_add_u32 v49, 128, v49
    v_and_b32 v120, 3, v119
    v_cmp_gt_u32 s[76:77], v48, v120
    v_add_u32 v120, 4, v120
    v_cmp_gt_u32 s[78:79], v48, v120
    v_mov_b32 v122, 2130706432
    v_add_u32 v121, 64, v49
    v_cndmask_b32 v120, v122, v49, s[76:77]
    v_cndmask_b32 v121, v122, v121, s[78:79]
    buffer_load_dwordx4 v[0:3], v120, s[8:11], 0 offen sc1
    buffer_load_dwordx4 v[4:7], v121, s[8:11], 0 offen sc1
    s_waitcnt vmcnt(0)
    v_cndmask_b32 v3, -1, v3, s[76:77]
    v_cndmask_b32 v7, -1, v7, s[78:79]
    v_mov_b32 v120, 1
    v_bfe_u32 v40, v3, 0, 4
    v_bfe_u32 v32, v3, 4, 4
    v_cmp_ne_u32 s[84:85], 15, v40
    v_lshl_add_u32 v72, v32, 2, s80
    v_bfe_u32 v41, v3, 8, 4
    v_bfe_u32 v33, v3, 12, 4
    v_cmp_ne_u32 s[86:87], 15, v41
    v_lshl_add_u32 v73, v33, 2, s80
    v_bfe_u32 v42, v3, 16, 4
    v_bfe_u32 v34, v3, 20, 4
    v_cmp_ne_u32 s[88:89], 15, v42
    v_lshl_add_u32 v74, v34, 2, s80
    v_bfe_u32 v43, v7, 0, 4
    v_bfe_u32 v35, v7, 4, 4
    v_cmp_ne_u32 s[90:91], 15, v43
    v_lshl_add_u32 v75, v35, 2, s80
    v_bfe_u32 v44, v7, 8, 4
    v_bfe_u32 v36, v7, 12, 4
    v_cmp_ne_u32 s[92:93], 15, v44
    v_lshl_add_u32 v76, v36, 2, s80
    v_bfe_u32 v45, v7, 16, 4
    v_bfe_u32 v37, v7, 20, 4
    v_cmp_ne_u32 s[94:95], 15, v45
    v_lshl_add_u32 v77, v37, 2, s80
    s_mov_b64 exec, s[84:85]
    ds_add_rtn_u32 v72, v72, v120
    s_mov_b64 exec, s[86:87]
    ds_add_rtn_u32 v73, v73, v120
    s_mov_b64 exec, s[88:89]
    ds_add_rtn_u32 v74, v74, v120
    s_mov_b64 exec, s[90:91]
    ds_add_rtn_u32 v75, v75, v120
    s_mov_b64 exec, s[92:93]
    ds_add_rtn_u32 v76, v76, v120
    s_mov_b64 exec, s[94:95]
    ds_add_rtn_u32 v77, v77, v120
    s_mov_b64 exec, -1
    v_lshlrev_b32 v40, v40, 1
    v_lshlrev_b32 v41, v41, 1
    v_lshlrev_b32 v42, v42, 1
    v_lshlrev_b32 v43, v43, 1
    v_lshlrev_b32 v44, v44, 1
    v_lshlrev_b32 v45, v45, 1
    s_waitcnt lgkmcnt(5)
    v_min_u32 v72, 287, v72
    v_mad_u32_u24 v32, v32, s83, v72
    v_lshl_add_u32 v72, v32, 2, s81
    v_lshl_add_u32 v32, v32, 1, s82
    s_waitcnt lgkmcnt(4)
    v_min_u32 v73, 287, v73
    v_mad_u32_u24 v33, v33, s83, v73
    v_lshl_add_u32 v73, v33, 2, s81
    v_lshl_add_u32 v33, v33, 1, s82
    s_waitcnt lgkmcnt(3)
    v_min_u32 v74, 287, v74
    v_mad_u32_u24 v34, v34, s83, v74
    v_lshl_add_u32 v74, v34, 2, s81
    v_lshl_add_u32 v34, v34, 1, s82
    s_waitcnt lgkmcnt(2)
    v_min_u32 v75, 287, v75
    v_mad_u32_u24 v35, v35, s83, v75
    v_lshl_add_u32 v75, v35, 2, s81
    v_lshl_add_u32 v35, v35, 1, s82
    s_waitcnt lgkmcnt(1)
    v_min_u32 v76, 287, v76
    v_mad_u32_u24 v36, v36, s83, v76
    v_lshl_add_u32 v76, v36, 2, s81
    v_lshl_add_u32 v36, v36, 1, s82
    s_waitcnt lgkmcnt(0)
    v_min_u32 v77, 287, v77
    v_mad_u32_u24 v37, v37, s83, v77
    v_lshl_add_u32 v77, v37, 2, s81
    v_lshl_add_u32 v37, v37, 1, s82
    s_mov_b64 exec, s[84:85]
    s_cbranch_execz BSK_7
    ds_write_b32 v72, v0
    ds_write_b16 v32, v40
BSK_7:
    s_mov_b64 exec, s[86:87]
    s_cbranch_execz BSK_8
    ds_write_b32 v73, v1
    ds_write_b16 v33, v41
BSK_8:
    s_mov_b64 exec, s[88:89]
    s_cbranch_execz BSK_9
    ds_write_b32 v74, v2
    ds_write_b16 v34, v42
BSK_9:
    s_mov_b64 exec, s[90:91]
    s_cbranch_execz BSK_10
    ds_write_b32 v75, v4
    ds_write_b16 v35, v43
BSK_10:
    s_mov_b64 exec, s[92:93]
    s_cbranch_execz BSK_11
    ds_write_b32 v76, v5
    ds_write_b16 v36, v44
BSK_11:
    s_mov_b64 exec, s[94:95]
    s_cbranch_execz BSK_12
    ds_write_b32 v77, v6
    ds_write_b16 v37, v45
BSK_12:
    s_mov_b64 exec, -1
    s_branch K_MORE
K_NOBIN:
    s_cmp_le_u32 s47, 12
    s_cbranch_scc1 SKA_13
    s_add_u32 m0, s51, 0
    s_nop 0
    buffer_load_dwordx4 v66, s[4:7], 0 offen lds
    s_add_u32 m0, s51, 1024
    s_nop 0
    buffer_load_dwordx4 v67, s[4:7], 0 offen lds
SKA_13:
    v_mov_b32 v0, 0
    v_mov_b32 v1, 0
    v_mov_b32 v2, 0
    v_mov_b32 v3, 0
    v_mov_b32 v4, 0
    v_mov_b32 v5, 0
    v_mov_b32 v6, 0
    v_mov_b32 v7, 0
    v_mov_b32 v8, 0
    v_mov_b32 v9, 0
    v_mov_b32 v10, 0
    v_mov_b32 v11, 0
    v_mov_b32 v12, 0
    v_mov_b32 v13, 0
    v_mov_b32 v14, 0
    v_mov_b32 v15, 0
    s_waitcnt lgkmcnt(0)
    s_barrier
    s_setprio 3
    v_mov_b32 v122, 154692
    ds_read_b32 v123, v122
    v_and_b32 v120, 31, v118
    v_lshl_add_u32 v120, v120, 2, s80
    ds_read_b32 v121, v120
    v_and_b32 v120, 16, v118
    v_cmp_eq_u32 s[78:79], 0, v120
    s_waitcnt lgkmcnt(0)
    v_readlane_b32 s59, v121, s3
    v_cmp_lt_u32 vcc, s83, v121
    s_and_b64 vcc, vcc, s[78:79]
    s_add_u32 s52, s59, 31
    s_lshr_b32 s52, s52, 5
    s_cmp_lg_u64 vcc, 0
    s_cselect_b32 s52, 0, s52
    s_cselect_b32 s58, 2, 0
    s_sub_u32 s98, s59, 1
    s_and_b32 s98, s98, 16
    v_readfirstlane_b32 s62, v123
    s_nop 3
    s_cmp_lg_u32 s62, 0
    s_cselect_b32 s52, 0, s52
    s_cselect_b32 s58, 3, s58
    ds_read_b128 v[72:75], v114 offset:0
    ds_read_b128 v[76:79], v114 offset:64
    ds_read_b64 v[80:81], v115 offset:0
    ds_read_b64 v[82:83], v115 offset:32
    s_waitcnt lgkmcnt(0)
    v_cndmask_b32 v68, v72, v73, s[74:75]
    v_cndmask_b32 v69, v74, v75, s[74:75]
    v_cndmask_b32 v70, v76, v77, s[74:75]
    v_cndmask_b32 v71, v78, v79, s[74:75]
    v_mad_u32_u16 v68, v68, s50, v112
    v_mad_u32_u16 v69, v69, s50, v113
    v_mad_u32_u16 v70, v70, s50, v112
    v_mad_u32_u16 v71, v71, s50, v113
    s_cmp_le_u32 s52, 0
    s_cbranch_scc1 SKD_14
    s_add_u32 m0, s51, 2048
    s_nop 0
    buffer_load_dwordx4 v68, s[4:7], 0 offen lds
    s_add_u32 m0, s51, 3072
    s_nop 0
    buffer_load_dwordx4 v69, s[4:7], 0 offen lds
SKD_14:
    v_pk_lshlrev_b16 v80, v116, v80
    v_pk_lshlrev_b16 v81, v116, v81
    v_pk_lshlrev_b16 v82, v116, v82
    v_pk_lshlrev_b16 v83, v116, v83
    v_perm_b32 v48, v73, v72, s48
    v_perm_b32 v49, v75, v74, s48
    v_perm_b32 v50, v77, v76, s48
    v_perm_b32 v51, v79, v78, s48
    v_pk_ashrrev_i16 v80, s49, v80
    v_pk_ashrrev_i16 v81, s49, v81
    v_pk_ashrrev_i16 v82, s49, v82
    v_pk_ashrrev_i16 v83, s49, v83
    v_and_b32 v48, v48, v80
    v_and_b32 v49, v49, v81
    v_and_b32 v50, v50, v82
    v_and_b32 v51, v51, v83
    ds_read_b128 v[72:75], v114 offset:128
    ds_read_b128 v[76:79], v114 offset:192
    ds_read_b64 v[80:81], v115 offset:64
    ds_read_b64 v[82:83], v115 offset:96
    s_cmp_eq_u32 s52, 0
    s_cbranch_scc1 WV_15
    s_waitcnt vmcnt(2)
    s_branch WV_16
WV_15:
    s_waitcnt vmcnt(0)
WV_16:
    s_waitcnt lgkmcnt(0)
    v_cndmask_b32 v60, v72, v73, s[74:75]
    v_cndmask_b32 v61, v74, v75, s[74:75]
    v_cndmask_b32 v62, v76, v77, s[74:75]
    v_cndmask_b32 v63, v78, v79, s[74:75]
    v_mad_u32_u16 v60, v60, s50, v112
    v_mad_u32_u16 v61, v61, s50, v113
    v_mad_u32_u16 v62, v62, s50, v112
    v_mad_u32_u16 v63, v63, s50, v113
    v_pk_lshlrev_b16 v80, v116, v80
    v_pk_lshlrev_b16 v81, v116, v81
    v_pk_lshlrev_b16 v82, v116, v82
    v_pk_lshlrev_b16 v83, v116, v83
    v_perm_b32 v52, v73, v72, s48
    v_perm_b32 v53, v75, v74, s48
    v_perm_b32 v54, v77, v76, s48
    v_perm_b32 v55, v79, v78, s48
    v_pk_ashrrev_i16 v80, s49, v80
    v_pk_ashrrev_i16 v81, s49, v81
    v_pk_ashrrev_i16 v82, s49, v82
    v_pk_ashrrev_i16 v83, s49, v83
    v_and_b32 v52, v52, v80
    v_and_b32 v53, v53, v81
    v_and_b32 v54, v54, v82
    v_and_b32 v55, v55, v83
    ds_read_b128 v[92:95], v124 offset:4096
    ds_read_b128 v[96:99], v125 offset:4096
    ds_read_b128 v[100:103], v124 offset:0
    ds_read_b128 v[104:107], v125 offset:0
    ds_read_b64_tr_b16 v[32:33], v108 offset:4096
    ds_read_b64_tr_b16 v[36:37], v109 offset:4096
    ds_read_b64_tr_b16 v[40:41], v110 offset:4096
    ds_read_b64_tr_b16 v[44:45], v111 offset:4096
    ds_read_b64_tr_b16 v[34:35], v108 offset:0
    ds_read_b64_tr_b16 v[38:39], v109 offset:0
    ds_read_b64_tr_b16 v[42:43], v110 offset:0
    ds_read_b64_tr_b16 v[46:47], v111 offset:0
    s_waitcnt lgkmcnt(0)
    s_cmp_eq_u32 s52, 0
    s_cbranch_scc1 SKD_17
    s_cmp_ge_u32 s52, 2
    s_cbranch_scc1 SKG_18
    s_cmp_eq_u32 s98, 0
    s_cbranch_scc1 SKD_17
SKG_18:
    s_add_u32 m0, s51, 4096
    s_nop 0
    buffer_load_dwordx4 v70, s[4:7], 0 offen lds
    s_add_u32 m0, s51, 5120
    s_nop 0
    buffer_load_dwordx4 v71, s[4:7], 0 offen lds
SKD_17:
    s_cmp_le_u32 s52, 1
    s_cbranch_scc1 SKD_19
    s_add_u32 m0, s51, 0
    s_nop 0
    buffer_load_dwordx4 v60, s[4:7], 0 offen lds
    s_add_u32 m0, s51, 1024
    s_nop 0
    buffer_load_dwordx4 v61, s[4:7], 0 offen lds
SKD_19:
    v_mfma_f32_16x16x32_bf16 v[56:59], v[92:95], v[84:87], 0
    v_mfma_f32_16x16x32_bf16 v[64:67], v[100:103], v[84:87], 0
    v_mfma_f32_16x16x32_bf16 v[56:59], v[96:99], v[88:91], v[56:59]
    v_mfma_f32_16x16x32_bf16 v[64:67], v[104:107], v[88:91], v[64:67]
    s_mov_b32 s54, 0x3e38aa3b
    s_mov_b32 s55, 0x3089705f
    s_nop 6
    v_cndmask_b32 v56, v56, v64, s[72:73]
    v_cndmask_b32 v57, v57, v65, s[72:73]
    v_cndmask_b32 v58, v58, v66, s[72:73]
    v_cndmask_b32 v59, v59, v67, s[72:73]
    v_mul_f32 v56, s54, v56
    v_mul_f32 v57, s54, v57
    v_mul_f32 v58, s54, v58
    v_mul_f32 v59, s54, v59
    v_exp_f32 v56, v56
    v_exp_f32 v57, v57
    v_exp_f32 v58, v58
    v_exp_f32 v59, v59
    s_nop 0
    v_add_f32 v120, v56, v57
    v_add_f32 v121, v58, v59
    v_add_f32 v120, v120, v121
    v_add_f32 v120, s55, v120
    v_rcp_f32 v120, v120
    s_nop 0
    v_mul_f32 v56, v120, v56
    v_mul_f32 v57, v120, v57
    v_mul_f32 v58, v120, v58
    v_mul_f32 v59, v120, v59
    v_cvt_pk_bf16_f32 v120, v56, v58
    v_cvt_pk_bf16_f32 v121, v57, v59
    v_cndmask_b32 v64, 0, v120, s[68:69]
    v_cndmask_b32 v65, 0, v121, s[68:69]
    v_cndmask_b32 v66, 0, v120, s[70:71]
    v_cndmask_b32 v67, 0, v121, s[70:71]
    s_nop 1
    v_mfma_f32_16x16x32_bf16 v[16:19], v[32:35], v[64:67], v[16:19]
    v_mfma_f32_16x16x32_bf16 v[20:23], v[36:39], v[64:67], v[20:23]
    v_mfma_f32_16x16x32_bf16 v[24:27], v[40:43], v[64:67], v[24:27]
    v_mfma_f32_16x16x32_bf16 v[28:31], v[44:47], v[64:67], v[28:31]
    v_and_b32 v120, 15, v118
    v_lshrrev_b32 v121, 5, v118
    v_and_b32 v122, 7, v118
    v_xor_b32 v121, v121, v122
    v_lshlrev_b32 v121, 4, v121
    v_lshl_add_u32 v120, v120, 7, v121
    v_bfe_u32 v121, v118, 4, 1
    v_lshl_add_u32 v120, v121, 3, v120
    v_add_u32 v120, s51, v120
    v_xor_b32 v121, 32, v120
    v_xor_b32 v122, 64, v120
    v_xor_b32 v123, 96, v120
    v_lshl_add_u32 v124, v118, 4, s51
    v_lshrrev_b32 v84, 3, v118
    v_and_b32 v85, 7, v118
    v_xor_b32 v85, v85, v84
    v_cmp_gt_u32 s[64:65], s47, v84
    v_add_u32 v86, 8, v84
    v_cmp_gt_u32 s[66:67], s47, v86
    v_add_u32 v84, s46, v84
    v_lshlrev_b32 v84, 7, v84
    v_lshl_add_u32 v125, v85, 4, v84
    ds_read_b128 v[92:95], v126 offset:16384
    ds_read_b128 v[96:99], v126 offset:17408
    ds_read_b128 v[100:103], v126 offset:18432
    ds_read_b128 v[104:107], v126 offset:19456
    v_cvt_pk_bf16_f32 v84, v16, v17
    v_cvt_pk_bf16_f32 v85, v18, v19
    v_cvt_pk_bf16_f32 v86, v20, v21
    v_cvt_pk_bf16_f32 v87, v22, v23
    v_cvt_pk_bf16_f32 v88, v24, v25
    v_cvt_pk_bf16_f32 v89, v26, v27
    v_cvt_pk_bf16_f32 v90, v28, v29
    v_cvt_pk_bf16_f32 v91, v30, v31
    s_waitcnt lgkmcnt(2)
    v_mfma_f32_16x16x32_bf16 v[16:19], v[92:95], v[84:87], 0
    v_mfma_f32_16x16x32_bf16 v[16:19], v[96:99], v[88:91], v[16:19]
    s_waitcnt lgkmcnt(0)
    v_mfma_f32_16x16x32_bf16 v[20:23], v[100:103], v[84:87], 0
    v_mfma_f32_16x16x32_bf16 v[20:23], v[104:107], v[88:91], v[20:23]
    ds_read_b128 v[92:95], v126 offset:20480
    ds_read_b128 v[96:99], v126 offset:21504
    ds_read_b128 v[100:103], v126 offset:22528
    ds_read_b128 v[104:107], v126 offset:23552
    s_waitcnt lgkmcnt(2)
    v_mfma_f32_16x16x32_bf16 v[24:27], v[92:95], v[84:87], 0
    v_mfma_f32_16x16x32_bf16 v[24:27], v[96:99], v[88:91], v[24:27]
    s_waitcnt lgkmcnt(0)
    v_mfma_f32_16x16x32_bf16 v[28:31], v[100:103], v[84:87], 0
    v_mfma_f32_16x16x32_bf16 v[28:31], v[104:107], v[88:91], v[28:31]
K_LOCAL:
    s_cmp_eq_u32 s52, 0
    s_cbranch_scc1 K_LOCAL_DONE
    s_cmp_eq_u32 s52, 1
    s_cbranch_scc1 K_LAST0
    s_mov_b32 s53, s52
    s_cmp_eq_u32 s52, 2
    s_cbranch_scc1 K_PEN0
K_FULL0:
    s_cmp_ge_u32 s53, 6
    s_cbranch_scc1 PR_20
    s_setprio 2
    s_cmp_ge_u32 s53, 4
    s_cbranch_scc1 PR_20
    s_setprio 1
PR_20:
    s_waitcnt vmcnt(4)
    ds_read_b64_tr_b16 v[32:33], v108 offset:2048
    ds_read_b64_tr_b16 v[36:37], v109 offset:2048
    ds_read_b64_tr_b16 v[40:41], v110 offset:2048
    ds_read_b64_tr_b16 v[44:45], v111 offset:2048
    ds_read_b128 v[72:75], v114 offset:256
    ds_read_b128 v[76:79], v114 offset:320
    ds_read_b64 v[80:81], v115 offset:128
    ds_read_b64 v[82:83], v115 offset:160
    s_waitcnt lgkmcnt(4)
    s_add_u32 m0, s51, 2048
    s_sub_u32 s53, s53, 1
    buffer_load_dwordx4 v62, s[4:7], 0 offen lds
    s_add_u32 m0, s51, 3072
    s_nop 0
    buffer_load_dwordx4 v63, s[4:7], 0 offen lds
    s_waitcnt vmcnt(4)
    ds_read_b64_tr_b16 v[34:35], v108 offset:4096
    ds_read_b64_tr_b16 v[38:39], v109 offset:4096
    ds_read_b64_tr_b16 v[42:43], v110 offset:4096
    ds_read_b64_tr_b16 v[46:47], v111 offset:4096
    s_waitcnt lgkmcnt(4)
    v_cndmask_b32 v64, v72, v73, s[74:75]
    v_cndmask_b32 v65, v74, v75, s[74:75]
    v_cndmask_b32 v66, v76, v77, s[74:75]
    v_cndmask_b32 v67, v78, v79, s[74:75]
    v_mad_u32_u16 v64, v64, s50, v112
    v_mad_u32_u16 v65, v65, s50, v113
    v_mad_u32_u16 v66, v66, s50, v112
    v_mad_u32_u16 v67, v67, s50, v113
    v_pk_lshlrev_b16 v80, v116, v80
    v_pk_lshlrev_b16 v81, v116, v81
    v_pk_lshlrev_b16 v82, v116, v82
    v_pk_lshlrev_b16 v83, v116, v83
    v_perm_b32 v56, v73, v72, s48
    v_perm_b32 v57, v75, v74, s48
    v_perm_b32 v58, v77, v76, s48
    v_perm_b32 v59, v79, v78, s48
    v_pk_ashrrev_i16 v80, s49, v80
    v_pk_ashrrev_i16 v81, s49, v81
    v_pk_ashrrev_i16 v82, s49, v82
    v_pk_ashrrev_i16 v83, s49, v83
    v_and_b32 v56, v56, v80
    v_and_b32 v57, v57, v81
    v_and_b32 v58, v58, v82
    v_and_b32 v59, v59, v83
    s_waitcnt lgkmcnt(0)
    s_add_u32 m0, s51, 4096
    s_nop 0
    buffer_load_dwordx4 v64, s[4:7], 0 offen lds
    s_add_u32 m0, s51, 5120
    s_nop 0
    buffer_load_dwordx4 v65, s[4:7], 0 offen lds
    v_mfma_f32_16x16x32_bf16 v[0:3], v[32:35], v[48:51], v[0:3]
    v_mfma_f32_16x16x32_bf16 v[4:7], v[36:39], v[48:51], v[4:7]
    v_mfma_f32_16x16x32_bf16 v[8:11], v[40:43], v[48:51], v[8:11]
    v_mfma_f32_16x16x32_bf16 v[12:15], v[44:47], v[48:51], v[12:15]
    s_cmp_eq_u32 s53, 2
    s_cbranch_scc1 K_PEN1
K_FULL1:
    s_cmp_ge_u32 s53, 6
    s_cbranch_scc1 PR_22
    s_setprio 2
    s_cmp_ge_u32 s53, 4
    s_cbranch_scc1 PR_22
    s_setprio 1
PR_22:
    s_waitcnt vmcnt(4)
    ds_read_b64_tr_b16 v[32:33], v108 offset:0
    ds_read_b64_tr_b16 v[36:37], v109 offset:0
    ds_read_b64_tr_b16 v[40:41], v110 offset:0
    ds_read_b64_tr_b16 v[44:45], v111 offset:0
    ds_read_b128 v[72:75], v114 offset:384
    ds_read_b128 v[76:79], v114 offset:448
    ds_read_b64 v[80:81], v115 offset:192
    ds_read_b64 v[82:83], v115 offset:224
    s_waitcnt lgkmcnt(4)
    s_add_u32 m0, s51, 0
    s_sub_u32 s53, s53, 1
    buffer_load_dwordx4 v66, s[4:7], 0 offen lds
    s_add_u32 m0, s51, 1024
    s_nop 0
    buffer_load_dwordx4 v67, s[4:7], 0 offen lds
    s_waitcnt vmcnt(4)
    ds_read_b64_tr_b16 v[34:35], v108 offset:2048
    ds_read_b64_tr_b16 v[38:39], v109 offset:2048
    ds_read_b64_tr_b16 v[42:43], v110 offset:2048
    ds_read_b64_tr_b16 v[46:47], v111 offset:2048
    s_waitcnt lgkmcnt(4)
    v_cndmask_b32 v68, v72, v73, s[74:75]
    v_cndmask_b32 v69, v74, v75, s[74:75]
    v_cndmask_b32 v70, v76, v77, s[74:75]
    v_cndmask_b32 v71, v78, v79, s[74:75]
    v_mad_u32_u16 v68, v68, s50, v112
    v_mad_u32_u16 v69, v69, s50, v113
    v_mad_u32_u16 v70, v70, s50, v112
    v_mad_u32_u16 v71, v71, s50, v113
    v_pk_lshlrev_b16 v80, v116, v80
    v_pk_lshlrev_b16 v81, v116, v81
    v_pk_lshlrev_b16 v82, v116, v82
    v_pk_lshlrev_b16 v83, v116, v83
    v_perm_b32 v48, v73, v72, s48
    v_perm_b32 v49, v75, v74, s48
    v_perm_b32 v50, v77, v76, s48
    v_perm_b32 v51, v79, v78, s48
    v_pk_ashrrev_i16 v80, s49, v80
    v_pk_ashrrev_i16 v81, s49, v81
    v_pk_ashrrev_i16 v82, s49, v82
    v_pk_ashrrev_i16 v83, s49, v83
    v_and_b32 v48, v48, v80
    v_and_b32 v49, v49, v81
    v_and_b32 v50, v50, v82
    v_and_b32 v51, v51, v83
    s_waitcnt lgkmcnt(0)
    s_add_u32 m0, s51, 2048
    s_nop 0
    buffer_load_dwordx4 v68, s[4:7], 0 offen lds
    s_add_u32 m0, s51, 3072
    s_nop 0
    buffer_load_dwordx4 v69, s[4:7], 0 offen lds
    v_mfma_f32_16x16x32_bf16 v[0:3], v[32:35], v[52:55], v[0:3]
    v_mfma_f32_16x16x32_bf16 v[4:7], v[36:39], v[52:55], v[4:7]
    v_mfma_f32_16x16x32_bf16 v[8:11], v[40:43], v[52:55], v[8:11]
    v_mfma_f32_16x16x32_bf16 v[12:15], v[44:47], v[52:55], v[12:15]
    s_cmp_eq_u32 s53, 2
    s_cbranch_scc1 K_PEN2
K_FULL2:
    s_cmp_ge_u32 s53, 6
    s_cbranch_scc1 PR_24
    s_setprio 2
    s_cmp_ge_u32 s53, 4
    s_cbranch_scc1 PR_24
    s_setprio 1
PR_24:
    s_waitcnt vmcnt(4)
    ds_read_b64_tr_b16 v[32:33], v108 offset:4096
    ds_read_b64_tr_b16 v[36:37], v109 offset:4096
    ds_read_b64_tr_b16 v[40:41], v110 offset:4096
    ds_read_b64_tr_b16 v[44:45], v111 offset:4096
    ds_read_b128 v[72:75], v114 offset:512
    ds_read_b128 v[76:79], v114 offset:576
    ds_read_b64 v[80:81], v115 offset:256
    ds_read_b64 v[82:83], v115 offset:288
    s_waitcnt lgkmcnt(4)
    s_add_u32 m0, s51, 4096
    s_sub_u32 s53, s53, 1
    buffer_load_dwordx4 v70, s[4:7], 0 offen lds
    s_add_u32 m0, s51, 5120
    s_nop 0
    buffer_load_dwordx4 v71, s[4:7], 0 offen lds
    s_waitcnt vmcnt(4)
    ds_read_b64_tr_b16 v[34:35], v108 offset:0
    ds_read_b64_tr_b16 v[38:39], v109 offset:0
    ds_read_b64_tr_b16 v[42:43], v110 offset:0
    ds_read_b64_tr_b16 v[46:47], v111 offset:0
    s_waitcnt lgkmcnt(4)
    v_cndmask_b32 v60, v72, v73, s[74:75]
    v_cndmask_b32 v61, v74, v75, s[74:75]
    v_cndmask_b32 v62, v76, v77, s[74:75]
    v_cndmask_b32 v63, v78, v79, s[74:75]
    v_mad_u32_u16 v60, v60, s50, v112
    v_mad_u32_u16 v61, v61, s50, v113
    v_mad_u32_u16 v62, v62, s50, v112
    v_mad_u32_u16 v63, v63, s50, v113
    v_pk_lshlrev_b16 v80, v116, v80
    v_pk_lshlrev_b16 v81, v116, v81
    v_pk_lshlrev_b16 v82, v116, v82
    v_pk_lshlrev_b16 v83, v116, v83
    v_perm_b32 v52, v73, v72, s48
    v_perm_b32 v53, v75, v74, s48
    v_perm_b32 v54, v77, v76, s48
    v_perm_b32 v55, v79, v78, s48
    v_pk_ashrrev_i16 v80, s49, v80
    v_pk_ashrrev_i16 v81, s49, v81
    v_pk_ashrrev_i16 v82, s49, v82
    v_pk_ashrrev_i16 v83, s49, v83
    v_and_b32 v52, v52, v80
    v_and_b32 v53, v53, v81
    v_and_b32 v54, v54, v82
    v_and_b32 v55, v55, v83
    s_waitcnt lgkmcnt(0)
    s_add_u32 m0, s51, 0
    v_add_u32 v114, 384, v114
    buffer_load_dwordx4 v60, s[4:7], 0 offen lds
    s_add_u32 m0, s51, 1024
    v_add_u32 v115, 192, v115
    buffer_load_dwordx4 v61, s[4:7], 0 offen lds
    v_mfma_f32_16x16x32_bf16 v[0:3], v[32:35], v[56:59], v[0:3]
    v_mfma_f32_16x16x32_bf16 v[4:7], v[36:39], v[56:59], v[4:7]
    v_mfma_f32_16x16x32_bf16 v[8:11], v[40:43], v[56:59], v[8:11]
    v_mfma_f32_16x16x32_bf16 v[12:15], v[44:47], v[56:59], v[12:15]
    s_cmp_eq_u32 s53, 2
    s_cbranch_scc1 K_PEN0
    s_branch K_FULL0
K_PEN0:
    s_setprio 0
    s_waitcnt vmcnt(4)
    ds_read_b64_tr_b16 v[32:33], v108 offset:2048
    ds_read_b64_tr_b16 v[36:37], v109 offset:2048
    ds_read_b64_tr_b16 v[40:41], v110 offset:2048
    ds_read_b64_tr_b16 v[44:45], v111 offset:2048
    s_waitcnt lgkmcnt(0)
    s_cmp_eq_u32 s98, 0
    s_cbranch_scc1 PH_26
    s_add_u32 m0, s51, 2048
    s_nop 0
    buffer_load_dwordx4 v62, s[4:7], 0 offen lds
    s_add_u32 m0, s51, 3072
    s_nop 0
    buffer_load_dwordx4 v63, s[4:7], 0 offen lds
    s_waitcnt vmcnt(4)
    s_branch PH_27
PH_26:
    s_waitcnt vmcnt(2)
PH_27:
    ds_read_b64_tr_b16 v[34:35], v108 offset:4096
    ds_read_b64_tr_b16 v[38:39], v109 offset:4096
    ds_read_b64_tr_b16 v[42:43], v110 offset:4096
    ds_read_b64_tr_b16 v[46:47], v111 offset:4096
    s_waitcnt lgkmcnt(0)
    v_mfma_f32_16x16x32_bf16 v[0:3], v[32:35], v[48:51], v[0:3]
    v_mfma_f32_16x16x32_bf16 v[4:7], v[36:39], v[48:51], v[4:7]
    v_mfma_f32_16x16x32_bf16 v[8:11], v[40:43], v[48:51], v[8:11]
    v_mfma_f32_16x16x32_bf16 v[12:15], v[44:47], v[48:51], v[12:15]
    s_branch K_LAST1
K_PEN1:
    s_setprio 0
    s_waitcnt vmcnt(4)
    ds_read_b64_tr_b16 v[32:33], v108 offset:0
    ds_read_b64_tr_b16 v[36:37], v109 offset:0
    ds_read_b64_tr_b16 v[40:41], v110 offset:0
    ds_read_b64_tr_b16 v[44:45], v111 offset:0
    s_waitcnt lgkmcnt(0)
    s_cmp_eq_u32 s98, 0
    s_cbranch_scc1 PH_28
    s_add_u32 m0, s51, 0
    s_nop 0
    buffer_load_dwordx4 v66, s[4:7], 0 offen lds
    s_add_u32 m0, s51, 1024
    s_nop 0
    buffer_load_dwordx4 v67, s[4:7], 0 offen lds
    s_waitcnt vmcnt(4)
    s_branch PH_29
PH_28:
    s_waitcnt vmcnt(2)
PH_29:
    ds_read_b64_tr_b16 v[34:35], v108 offset:2048
    ds_read_b64_tr_b16 v[38:39], v109 offset:2048
    ds_read_b64_tr_b16 v[42:43], v110 offset:2048
    ds_read_b64_tr_b16 v[46:47], v111 offset:2048
    s_waitcnt lgkmcnt(0)
    v_mfma_f32_16x16x32_bf16 v[0:3], v[32:35], v[52:55], v[0:3]
    v_mfma_f32_16x16x32_bf16 v[4:7], v[36:39], v[52:55], v[4:7]
    v_mfma_f32_16x16x32_bf16 v[8:11], v[40:43], v[52:55], v[8:11]
    v_mfma_f32_16x16x32_bf16 v[12:15], v[44:47], v[52:55], v[12:15]
    s_branch K_LAST2
K_PEN2:
    s_setprio 0
    s_waitcnt vmcnt(4)
    ds_read_b64_tr_b16 v[32:33], v108 offset:4096
    ds_read_b64_tr_b16 v[36:37], v109 offset:4096
    ds_read_b64_tr_b16 v[40:41], v110 offset:4096
    ds_read_b64_tr_b16 v[44:45], v111 offset:4096
    s_waitcnt lgkmcnt(0)
    s_cmp_eq_u32 s98, 0
    s_cbranch_scc1 PH_30
    s_add_u32 m0, s51, 4096
    s_nop 0
    buffer_load_dwordx4 v70, s[4:7], 0 offen lds
    s_add_u32 m0, s51, 5120
    s_nop 0
    buffer_load_dwordx4 v71, s[4:7], 0 offen lds
    s_waitcnt vmcnt(4)
    s_branch PH_31
PH_30:
    s_waitcnt vmcnt(2)
PH_31:
    ds_read_b64_tr_b16 v[34:35], v108 offset:0
    ds_read_b64_tr_b16 v[38:39], v109 offset:0
    ds_read_b64_tr_b16 v[42:43], v110 offset:0
    ds_read_b64_tr_b16 v[46:47], v111 offset:0
    s_waitcnt lgkmcnt(0)
    v_mfma_f32_16x16x32_bf16 v[0:3], v[32:35], v[56:59], v[0:3]
    v_mfma_f32_16x16x32_bf16 v[4:7], v[36:39], v[56:59], v[4:7]
    v_mfma_f32_16x16x32_bf16 v[8:11], v[40:43], v[56:59], v[8:11]
    v_mfma_f32_16x16x32_bf16 v[12:15], v[44:47], v[56:59], v[12:15]
    s_branch K_LAST0
K_LAST0:
    s_setprio 0
    s_cmp_eq_u32 s98, 0
    s_cbranch_scc1 LH_32
    s_waitcnt vmcnt(2)
    s_branch LH_33
LH_32:
    s_waitcnt vmcnt(0)
LH_33:
    ds_read_b64_tr_b16 v[32:33], v108 offset:2048
    ds_read_b64_tr_b16 v[36:37], v109 offset:2048
    ds_read_b64_tr_b16 v[40:41], v110 offset:2048
    ds_read_b64_tr_b16 v[44:45], v111 offset:2048
    s_waitcnt vmcnt(0)
    ds_read_b64_tr_b16 v[34:35], v108 offset:4096
    ds_read_b64_tr_b16 v[38:39], v109 offset:4096
    ds_read_b64_tr_b16 v[42:43], v110 offset:4096
    ds_read_b64_tr_b16 v[46:47], v111 offset:4096
    s_waitcnt lgkmcnt(0)
    v_mfma_f32_16x16x32_bf16 v[0:3], v[32:35], v[48:51], v[0:3]
    v_mfma_f32_16x16x32_bf16 v[4:7], v[36:39], v[48:51], v[4:7]
    v_mfma_f32_16x16x32_bf16 v[8:11], v[40:43], v[48:51], v[8:11]
    v_mfma_f32_16x16x32_bf16 v[12:15], v[44:47], v[48:51], v[12:15]
    s_branch K_LOCAL_DONE
K_LAST1:
    s_setprio 0
    s_cmp_eq_u32 s98, 0
    s_cbranch_scc1 LH_34
    s_waitcnt vmcnt(2)
    s_branch LH_35
LH_34:
    s_waitcnt vmcnt(0)
LH_35:
    ds_read_b64_tr_b16 v[32:33], v108 offset:0
    ds_read_b64_tr_b16 v[36:37], v109 offset:0
    ds_read_b64_tr_b16 v[40:41], v110 offset:0
    ds_read_b64_tr_b16 v[44:45], v111 offset:0
    s_waitcnt vmcnt(0)
    ds_read_b64_tr_b16 v[34:35], v108 offset:2048
    ds_read_b64_tr_b16 v[38:39], v109 offset:2048
    ds_read_b64_tr_b16 v[42:43], v110 offset:2048
    ds_read_b64_tr_b16 v[46:47], v111 offset:2048
    s_waitcnt lgkmcnt(0)
    v_mfma_f32_16x16x32_bf16 v[0:3], v[32:35], v[52:55], v[0:3]
    v_mfma_f32_16x16x32_bf16 v[4:7], v[36:39], v[52:55], v[4:7]
    v_mfma_f32_16x16x32_bf16 v[8:11], v[40:43], v[52:55], v[8:11]
    v_mfma_f32_16x16x32_bf16 v[12:15], v[44:47], v[52:55], v[12:15]
    s_branch K_LOCAL_DONE
K_LAST2:
    s_setprio 0
    s_cmp_eq_u32 s98, 0
    s_cbranch_scc1 LH_36
    s_waitcnt vmcnt(2)
    s_branch LH_37
LH_36:
    s_waitcnt vmcnt(0)
LH_37:
    ds_read_b64_tr_b16 v[32:33], v108 offset:4096
    ds_read_b64_tr_b16 v[36:37], v109 offset:4096
    ds_read_b64_tr_b16 v[40:41], v110 offset:4096
    ds_read_b64_tr_b16 v[44:45], v111 offset:4096
    s_waitcnt vmcnt(0)
    ds_read_b64_tr_b16 v[34:35], v108 offset:0
    ds_read_b64_tr_b16 v[38:39], v109 offset:0
    ds_read_b64_tr_b16 v[42:43], v110 offset:0
    ds_read_b64_tr_b16 v[46:47], v111 offset:0
    s_waitcnt lgkmcnt(0)
    v_mfma_f32_16x16x32_bf16 v[0:3], v[32:35], v[56:59], v[0:3]
    v_mfma_f32_16x16x32_bf16 v[4:7], v[36:39], v[56:59], v[4:7]
    v_mfma_f32_16x16x32_bf16 v[8:11], v[40:43], v[56:59], v[8:11]
    v_mfma_f32_16x16x32_bf16 v[12:15], v[44:47], v[56:59], v[12:15]
K_LOCAL_DONE:
    s_cmp_eq_u32 s58, 0
    s_cbranch_scc1 K_EPI
    s_cmp_eq_u32 s58, 1
    s_cbranch_scc1 K_SLOW_TOP
    s_cmp_eq_u32 s58, 3
    s_cselect_b32 s62, 1, 0
    s_mov_b32 s61, 0
    s_mov_b32 s63, 0
K_SLOW_TOP:
    s_barrier
    v_mov_b32 v32, 0xffff
    v_mov_b32 v33, 0xffff
    v_mov_b32 v34, 0xffff
    v_mov_b32 v35, 0xffff
    s_mul_i32 s54, s3, 1152
    s_add_u32 s54, s54, 126976
    v_lshl_add_u32 v120, v118, 4, s54
    s_lshl_b32 s55, s3, 2
    s_add_u32 s55, s55, 154624
    v_mov_b32 v121, 0
    v_mov_b32 v122, s55
    ds_write_b128 v120, v[32:35]
    s_mov_b64 exec, 0xff
    ds_write_b128 v120, v[32:35] offset:1024
    s_mov_b64 exec, 1
    ds_write_b32 v122, v121
    s_mov_b64 exec, -1
    s_mul_i32 s54, s3, 1152
    s_add_u32 s54, s54, 126976
    v_lshrrev_b32 v120, 4, v118
    v_lshl_add_u32 v114, v120, 4, s54
    s_mul_i32 s54, s3, 576
    s_add_u32 s54, s54, 145408
    v_lshl_add_u32 v115, v120, 3, s54
    v_mov_b32 v93, -1
    v_mov_b32 v92, 0xffff
    s_cmp_lg_u32 s62, 0
    s_cbranch_scc1 K_SLOW_RAW
K_SLOW_CH:
    s_cmp_ge_u32 s61, 256
    s_cbranch_scc1 K_EPI_SLOW
    s_lshl_b32 s54, s61, 10
    s_lshl_b32 s55, s60, 2
    s_add_u32 s54, s54, s55
    s_add_u32 s54, s54, 5242880
    v_mov_b32 v120, 0
    buffer_load_dword v121, v120, s[8:11], s54 offen sc1
    s_waitcnt vmcnt(0)
    v_readfirstlane_b32 s55, v121
    s_nop 3
    s_lshr_b32 s56, s55, 16
    s_and_b32 s55, s55, 0xffff
    s_cmp_lt_u32 s63, s56
    s_cbranch_scc1 K_SLOW_CH1
    s_add_u32 s61, s61, 1
    s_mov_b32 s63, 0
    s_branch K_SLOW_CH
K_SLOW_CH1:
    v_lshrrev_b32 v120, 2, v119
    v_add_u32 v120, s63, v120
    v_and_b32 v122, 3, v119
    v_cmp_gt_u32 s[78:79], s56, v120
    v_cmp_gt_u32 vcc, 3, v122
    s_and_b64 s[78:79], s[78:79], vcc
    v_cmp_gt_u32 vcc, 256, v119
    s_and_b64 vcc, vcc, s[78:79]
    s_add_u32 s63, s63, 64
    v_add_u32 v120, s55, v120
    v_lshlrev_b32 v121, 4, v120
    v_lshl_add_u32 v123, v122, 2, v121
    v_add_u32 v121, v121, v122
    s_mul_i32 s55, s61, 20480
    s_add_u32 s55, s55, 0
    s_and_saveexec_b64 s[76:77], vcc
    s_cbranch_execz K_SLOW_S1
    buffer_load_dword v92, v123, s[8:11], s55 offen sc1
    buffer_load_ubyte v93, v121, s[8:11], s55 offen offset:12 sc1
K_SLOW_S1:
    s_mov_b64 exec, s[76:77]
    s_waitcnt vmcnt(0)
    s_branch K_SLOW_BIN
K_SLOW_RAW:
    s_cmp_ge_u32 s61, 3125
    s_cbranch_scc1 K_EPI_SLOW
    s_lshl_b32 s54, s61, 10
    s_add_u32 s61, s61, 1
    v_lshlrev_b32 v120, 2, v119
    v_cmp_gt_u32 vcc, 256, v119
    s_and_saveexec_b64 s[76:77], vcc
    s_cbranch_execz K_SLOW_O2
    s_mov_b32 s16, s26
    s_and_b32 s17, s27, 0xffff
    s_mov_b32 s18, 3200000
    s_mov_b32 s19, 0x00020000
    s_mov_b32 s20, s24
    s_and_b32 s21, s25, 0xffff
    s_mov_b32 s22, 3200000
    s_mov_b32 s23, 0x00020000
    buffer_load_dword v122, v120, s[16:19], s54 offen
    buffer_load_dword v92, v120, s[20:23], s54 offen
    s_mov_b32 s16, s30
    s_and_b32 s17, s31, 0xffff
    s_mov_b32 s18, 100000
    s_mov_b32 s19, 0x00020000
    s_waitcnt vmcnt(0)
    v_lshlrev_b32 v123, 1, v92
    buffer_load_ushort v123, v123, s[16:19], 0 offen
    s_waitcnt vmcnt(0)
    v_lshl_or_b32 v92, v123, 16, v92
    v_lshlrev_b32 v120, 8, v122
    s_mov_b32 s57, 1369569
    v_mul_hi_u32_u24 v120, s57, v120
    v_lshlrev_b32 v121, 2, v122
    s_mov_b32 s57, -49
    v_mad_i32_i24 v121, v120, s57, v121
    v_lshrrev_b32 v121, 2, v121
    v_and_b32 v124, 15, v120
    v_lshl_or_b32 v121, v124, 4, v121
    v_lshrrev_b32 v120, 4, v120
    v_cmp_eq_u32 vcc, s60, v120
    v_mov_b32 v120, 0xff
    s_nop 0
    v_cndmask_b32 v93, v120, v121, vcc
K_SLOW_O2:
    s_mov_b64 exec, s[76:77]
K_SLOW_BIN:
    s_waitcnt lgkmcnt(0)
    s_barrier
    v_bfe_u32 v40, v93, 0, 4
    v_bfe_u32 v32, v93, 4, 4
    v_cmp_ne_u32 s[84:85], 15, v40
    v_lshl_add_u32 v72, v32, 2, s80
    v_mov_b32 v120, 1
    s_mov_b64 exec, s[84:85]
    ds_add_rtn_u32 v72, v72, v120
    v_lshlrev_b32 v40, v40, 1
    s_waitcnt lgkmcnt(0)
    v_mad_u32_u24 v32, v32, s83, v72
    v_lshl_add_u32 v72, v32, 2, s81
    v_lshl_add_u32 v32, v32, 1, s82
    ds_write_b32 v72, v92
    ds_write_b16 v32, v40
    s_mov_b64 exec, -1
    s_waitcnt lgkmcnt(0)
    s_barrier
    v_and_b32 v120, 31, v118
    v_lshl_add_u32 v120, v120, 2, s80
    ds_read_b32 v121, v120
    v_and_b32 v120, 16, v118
    v_cmp_eq_u32 s[78:79], 0, v120
    s_waitcnt lgkmcnt(0)
    v_readlane_b32 s59, v121, s3
    v_cmp_lt_u32 vcc, s83, v121
    s_and_b64 vcc, vcc, s[78:79]
    s_add_u32 s52, s59, 31
    s_lshr_b32 s52, s52, 5
    s_cmp_lg_u64 vcc, 0
    s_cselect_b32 s52, 0, s52
    s_cselect_b32 s58, 2, 0
    s_sub_u32 s98, s59, 1
    s_and_b32 s98, s98, 16
    s_mov_b32 s58, 1
    ds_read_b128 v[72:75], v114 offset:0
    ds_read_b128 v[76:79], v114 offset:64
    ds_read_b64 v[80:81], v115 offset:0
    ds_read_b64 v[82:83], v115 offset:32
    s_waitcnt lgkmcnt(0)
    v_cndmask_b32 v68, v72, v73, s[74:75]
    v_cndmask_b32 v69, v74, v75, s[74:75]
    v_cndmask_b32 v70, v76, v77, s[74:75]
    v_cndmask_b32 v71, v78, v79, s[74:75]
    v_mad_u32_u16 v68, v68, s50, v112
    v_mad_u32_u16 v69, v69, s50, v113
    v_mad_u32_u16 v70, v70, s50, v112
    v_mad_u32_u16 v71, v71, s50, v113
    v_pk_lshlrev_b16 v80, v116, v80
    v_pk_lshlrev_b16 v81, v116, v81
    v_pk_lshlrev_b16 v82, v116, v82
    v_pk_lshlrev_b16 v83, v116, v83
    v_perm_b32 v48, v73, v72, s48
    v_perm_b32 v49, v75, v74, s48
    v_perm_b32 v50, v77, v76, s48
    v_perm_b32 v51, v79, v78, s48
    v_pk_ashrrev_i16 v80, s49, v80
    v_pk_ashrrev_i16 v81, s49, v81
    v_pk_ashrrev_i16 v82, s49, v82
    v_pk_ashrrev_i16 v83, s49, v83
    v_and_b32 v48, v48, v80
    v_and_b32 v49, v49, v81
    v_and_b32 v50, v50, v82
    v_and_b32 v51, v51, v83
    ds_read_b128 v[72:75], v114 offset:128
    ds_read_b128 v[76:79], v114 offset:192
    ds_read_b64 v[80:81], v115 offset:64
    ds_read_b64 v[82:83], v115 offset:96
    s_waitcnt lgkmcnt(0)
    v_cndmask_b32 v60, v72, v73, s[74:75]
    v_cndmask_b32 v61, v74, v75, s[74:75]
    v_cndmask_b32 v62, v76, v77, s[74:75]
    v_cndmask_b32 v63, v78, v79, s[74:75]
    v_mad_u32_u16 v60, v60, s50, v112
    v_mad_u32_u16 v61, v61, s50, v113
    v_mad_u32_u16 v62, v62, s50, v112
    v_mad_u32_u16 v63, v63, s50, v113
    v_pk_lshlrev_b16 v80, v116, v80
    v_pk_lshlrev_b16 v81, v116, v81
    v_pk_lshlrev_b16 v82, v116, v82
    v_pk_lshlrev_b16 v83, v116, v83
    v_perm_b32 v52, v73, v72, s48
    v_perm_b32 v53, v75, v74, s48
    v_perm_b32 v54, v77, v76, s48
    v_perm_b32 v55, v79, v78, s48
    v_pk_ashrrev_i16 v80, s49, v80
    v_pk_ashrrev_i16 v81, s49, v81
    v_pk_ashrrev_i16 v82, s49, v82
    v_pk_ashrrev_i16 v83, s49, v83
    v_and_b32 v52, v52, v80
    v_and_b32 v53, v53, v81
    v_and_b32 v54, v54, v82
    v_and_b32 v55, v55, v83
    s_cmp_le_u32 s52, 0
    s_cbranch_scc1 SKD_38
    s_add_u32 m0, s51, 2048
    s_nop 0
    buffer_load_dwordx4 v68, s[4:7], 0 offen lds
    s_add_u32 m0, s51, 3072
    s_nop 0
    buffer_load_dwordx4 v69, s[4:7], 0 offen lds
SKD_38:
    s_cmp_eq_u32 s52, 0
    s_cbranch_scc1 SKD_39
    s_cmp_ge_u32 s52, 2
    s_cbranch_scc1 SKG_40
    s_cmp_eq_u32 s98, 0
    s_cbranch_scc1 SKD_39
SKG_40:
    s_add_u32 m0, s51, 4096
    s_nop 0
    buffer_load_dwordx4 v70, s[4:7], 0 offen lds
    s_add_u32 m0, s51, 5120
    s_nop 0
    buffer_load_dwordx4 v71, s[4:7], 0 offen lds
SKD_39:
    s_cmp_le_u32 s52, 1
    s_cbranch_scc1 SKD_41
    s_add_u32 m0, s51, 0
    s_nop 0
    buffer_load_dwordx4 v60, s[4:7], 0 offen lds
    s_add_u32 m0, s51, 1024
    s_nop 0
    buffer_load_dwordx4 v61, s[4:7], 0 offen lds
SKD_41:
    s_branch K_LOCAL
K_EPI_SLOW:
    v_and_b32 v120, 15, v118
    v_lshrrev_b32 v121, 5, v118
    v_and_b32 v122, 7, v118
    v_xor_b32 v121, v121, v122
    v_lshlrev_b32 v121, 4, v121
    v_lshl_add_u32 v120, v120, 7, v121
    v_bfe_u32 v121, v118, 4, 1
    v_lshl_add_u32 v120, v121, 3, v120
    v_add_u32 v120, s51, v120
    v_xor_b32 v121, 32, v120
    v_xor_b32 v122, 64, v120
    v_xor_b32 v123, 96, v120
    v_lshl_add_u32 v124, v118, 4, s51
    v_lshrrev_b32 v84, 3, v118
    v_and_b32 v85, 7, v118
    v_xor_b32 v85, v85, v84
    v_cmp_gt_u32 s[64:65], s47, v84
    v_add_u32 v86, 8, v84
    v_cmp_gt_u32 s[66:67], s47, v86
    v_add_u32 v84, s46, v84
    v_lshlrev_b32 v84, 7, v84
    v_lshl_add_u32 v125, v85, 4, v84
K_EPI:
    ds_read_b128 v[92:95], v126 offset:8192
    ds_read_b128 v[96:99], v126 offset:9216
    ds_read_b128 v[100:103], v126 offset:10240
    ds_read_b128 v[104:107], v126 offset:11264
    ds_read_b128 v[72:75], v126 offset:12288
    ds_read_b128 v[76:79], v126 offset:13312
    ds_read_b128 v[84:87], v126 offset:14336
    ds_read_b128 v[88:91], v126 offset:15360
    v_lshlrev_b32 v117, 16, v117
    v_mov_b32 v36, 2130706432
    v_add_u32 v35, 1024, v125
    v_cndmask_b32 v34, v36, v125, s[64:65]
    v_cndmask_b32 v35, v36, v35, s[66:67]
    s_nop 2
    v_mul_f32 v0, v117, v0
    v_mul_f32 v1, v117, v1
    v_mul_f32 v2, v117, v2
    v_mul_f32 v3, v117, v3
    v_mul_f32 v4, v117, v4
    v_mul_f32 v5, v117, v5
    v_mul_f32 v6, v117, v6
    v_mul_f32 v7, v117, v7
    v_mul_f32 v8, v117, v8
    v_mul_f32 v9, v117, v9
    v_mul_f32 v10, v117, v10
    v_mul_f32 v11, v117, v11
    v_mul_f32 v12, v117, v12
    v_mul_f32 v13, v117, v13
    v_mul_f32 v14, v117, v14
    v_mul_f32 v15, v117, v15
    v_cvt_pk_bf16_f32 v48, v0, v1
    v_cvt_pk_bf16_f32 v49, v2, v3
    v_cvt_pk_bf16_f32 v50, v4, v5
    v_cvt_pk_bf16_f32 v51, v6, v7
    v_cvt_pk_bf16_f32 v52, v8, v9
    v_cvt_pk_bf16_f32 v53, v10, v11
    v_cvt_pk_bf16_f32 v54, v12, v13
    v_cvt_pk_bf16_f32 v55, v14, v15
    s_waitcnt lgkmcnt(0)
    v_mfma_f32_16x16x32_bf16 v[16:19], v[92:95], v[48:51], v[16:19]
    v_mfma_f32_16x16x32_bf16 v[20:23], v[100:103], v[48:51], v[20:23]
    v_mfma_f32_16x16x32_bf16 v[24:27], v[72:75], v[48:51], v[24:27]
    v_mfma_f32_16x16x32_bf16 v[28:31], v[84:87], v[48:51], v[28:31]
    v_mfma_f32_16x16x32_bf16 v[16:19], v[96:99], v[52:55], v[16:19]
    v_mfma_f32_16x16x32_bf16 v[20:23], v[104:107], v[52:55], v[20:23]
    v_mfma_f32_16x16x32_bf16 v[24:27], v[76:79], v[52:55], v[24:27]
    v_mfma_f32_16x16x32_bf16 v[28:31], v[88:91], v[52:55], v[28:31]
    s_nop 4
    v_cvt_pk_bf16_f32 v0, v16, v17
    v_cvt_pk_bf16_f32 v1, v18, v19
    ds_write_b64 v120, v[0:1]
    v_cvt_pk_bf16_f32 v2, v20, v21
    v_cvt_pk_bf16_f32 v3, v22, v23
    ds_write_b64 v121, v[2:3]
    v_cvt_pk_bf16_f32 v4, v24, v25
    v_cvt_pk_bf16_f32 v5, v26, v27
    ds_write_b64 v122, v[4:5]
    v_cvt_pk_bf16_f32 v6, v28, v29
    v_cvt_pk_bf16_f32 v7, v30, v31
    ds_write_b64 v123, v[6:7]
    s_waitcnt lgkmcnt(0)
    ds_read_b128 v[16:19], v124
    ds_read_b128 v[20:23], v124 offset:1024
    s_waitcnt lgkmcnt(1)
    buffer_store_dwordx4 v[16:19], v34, s[12:15], 0 offen sc1
    s_waitcnt lgkmcnt(0)
    buffer_store_dwordx4 v[20:23], v35, s[12:15], 0 offen sc1
K_END:
    s_endpgm
.section .rodata,"a"
.p2align 6
.amdhsa_kernel standalone__hybrid_graph_tf_exphormer__graph_kernel
  .amdhsa_next_free_vgpr 128
  .amdhsa_next_free_sgpr 102
  .amdhsa_accum_offset 128
  .amdhsa_group_segment_fixed_size 0
  .amdhsa_kernarg_size 104
  .amdhsa_user_sgpr_count 2
  .amdhsa_user_sgpr_kernarg_segment_ptr 1
  .amdhsa_system_sgpr_workgroup_id_x 1
  .amdhsa_float_denorm_mode_32 3
.end_amdhsa_kernel
```
